```python
import torch

def _softmax(x, axis=-1):
    return torch.softmax(x, dim=axis)
def _gelu(x):
    return torch.nn.functional.gelu(x, approximate="tanh")
def _silu(x):
    return torch.nn.functional.silu(x)
def _sigmoid(x):
    return torch.sigmoid(x)
def _layernorm(x, axis=-1, eps=1e-5):
    m = x.mean(dim=axis, keepdim=True)
    v = x.var(dim=axis, keepdim=True, unbiased=False)
    return (x - m) / torch.sqrt(v + eps)
def _scatter_add(tgt, idx, src, axis=0):
    return tgt.clone().index_add_(axis, idx, src)
def _segment_sum(src, seg, n):
    out = torch.zeros((n,) + src.shape[1:], dtype=src.dtype)
    return out.index_add_(0, seg, src)
def _pad(x, pw):
    flat = tuple(v for pair in reversed(pw) for v in pair)
    return torch.nn.functional.pad(x, flat)

kernel_name = 'sequential_preLN__spectral_fnet__dense_activation_relu__prompt'

def setup_inputs():

    _w = (lambda a: (lambda t: t.to(torch.bfloat16) if t.is_floating_point() else t)(torch.as_tensor(a)))
    def _A_setup():
        B, S, D = 1, 2048, 512
        ns = torch.arange(S)[:, None] * torch.arange(S)[None, :]
        nd = torch.arange(D)[:, None] * torch.arange(D)[None, :]
        Ws_re = torch.cos(-2.0 * torch.pi * ns / S).to(float)
        Ws_im = torch.sin(-2.0 * torch.pi * ns / S).to(float)
        Wd_re = torch.cos(-2.0 * torch.pi * nd / D).to(float)
        Wd_im = torch.sin(-2.0 * torch.pi * nd / D).to(float)
        return {
            "x": _w((lambda *s: torch.randn(*s, dtype=torch.bfloat16) * 0.05)(B, S, D)),
            "dft_seq_re": _w(Ws_re),
            "dft_seq_im": _w(Ws_im),
            "dft_hid_re": _w(Wd_re),
            "dft_hid_im": _w(Wd_im),
        }
    _A_in = _A_setup()

    def _B_setup():
        B, S, D, Dff = 1, 2048, 512, 1792
        return {
            "x": _w((lambda *s: torch.randn(*s, dtype=torch.bfloat16) * 0.05)(B, S, D)),
            "w1": _w((lambda *s: torch.randn(*s, dtype=torch.bfloat16) * 0.4)(D, Dff)),
            "w2": _w((lambda *s: torch.randn(*s, dtype=torch.bfloat16) * 0.4)(Dff, D)),
        }
    _B_in = _B_setup()

    return {
        "A_x": _A_in["x"],
        "A_dft_seq_re": _A_in["dft_seq_re"],
        "A_dft_seq_im": _A_in["dft_seq_im"],
        "A_dft_hid_re": _A_in["dft_hid_re"],
        "A_dft_hid_im": _A_in["dft_hid_im"],
        "B_x": _B_in["x"],
        "B_w1": _B_in["w1"],
        "B_w2": _B_in["w2"],
    }

def reference(A_x, A_dft_seq_re, A_dft_seq_im, A_dft_hid_re, A_dft_hid_im, B_x, B_w1, B_w2):
    def _A_ref(x, dft_seq_re, dft_seq_im, dft_hid_re, dft_hid_im):
        a = torch.einsum("bsd,ed->bse", x, dft_hid_re)
        b = torch.einsum("bsd,ed->bse", x, dft_hid_im)
        y = torch.einsum("ts,bse->bte", dft_seq_re, a) - torch.einsum("ts,bse->bte", dft_seq_im, b)
        return y

    def _B_ref(x, w1, w2):
        h = torch.einsum("bsd,df->bsf", x, w1)
        zero = torch.zeros_like(h)
        h = torch.maximum(h, zero)
        return torch.einsum("bsf,fd->bsd", h, w2)

    x = A_x
    h = x + _A_ref(_layernorm(x, axis=-1), A_dft_seq_re, A_dft_seq_im, A_dft_hid_re, A_dft_hid_im)
    h2 = h + _B_ref(_layernorm(h, axis=-1), B_w1, B_w2)
    return h2
```

```asm
; @launch grid=(256,1,1) block=(512,1,1) lds=147968
.amdgcn_target "amdgcn-amd-amdhsa--gfx950"
.text
.globl sequential_preLN__spectral_fnet__dense_activation_relu__prompt_kernel
.p2align 8
.type sequential_preLN__spectral_fnet__dense_activation_relu__prompt_kernel,@function
sequential_preLN__spectral_fnet__dense_activation_relu__prompt_kernel:
    s_cmp_ge_u32 s2, 256
    s_cbranch_scc1 KC_END
    s_load_dwordx2 s[4:5], s[0:1], 0
    s_load_dwordx2 s[10:11], s[0:1], 80
    s_load_dwordx4 s[44:47], s[0:1], 48
    s_load_dwordx4 s[68:71], s[0:1], 64
    s_memrealtime s[72:73]
    s_and_b32 s28, s2, 7
    s_lshr_b32 s29, s2, 3
    s_and_b32 s30, s29, 3
    s_lshr_b32 s29, s29, 2
    s_lshl_b32 s29, s29, 3
    s_add_u32 s28, s28, s29
    v_lshrrev_b32 v1, 6, v0
    s_nop 0
    v_readfirstlane_b32 s31, v1
    v_and_b32 v1, 63, v0
    v_and_b32 v2, 15, v0
    v_lshrrev_b32 v3, 4, v1
    s_and_b32 s32, s31, 3
    s_lshr_b32 s33, s31, 2
    v_lshlrev_b32 v4, 16, v3
    v_lshl_add_u32 v5, v2, 4, v4
    v_lshlrev_b32 v6, 4, v2
    v_sub_u32 v6, 752, v6
    v_add_u32 v6, v4, v6
    s_lshl_b32 s36, s31, 18
    s_lshl_b32 s37, s28, 10
    s_add_u32 s36, s36, s37
    s_lshl_b32 s38, s30, 6
    s_lshl_b32 s39, s32, 4
    s_add_u32 s38, s38, s39
    s_min_u32 s49, s31, 6
    v_lshrrev_b32 v120, 2, v1
    v_and_b32 v121, 3, v1
    s_cmp_ge_u32 s28, 32
    s_cbranch_scc1 K1_PREP2
    s_and_b32 s50, s28, 15
    s_lshr_b32 s51, s28, 4
    s_lshl_b32 s51, s51, 2
    s_add_u32 s51, s51, s30
    s_mul_i32 s51, s51, 7
    s_add_u32 s51, s51, s49
    s_lshl_b32 s56, s50, 5
    v_add_u32 v120, s56, v120
    v_add_u32 v122, 16, v120
    s_movk_i32 s56, 0x100
    v_sub_u32 v123, 0x300, v120
    v_cmp_lt_u32 vcc, s56, v120
    s_nop 1
    v_cndmask_b32 v120, v120, v123, vcc
    v_sub_u32 v123, 0x300, v122
    v_cmp_lt_u32 vcc, s56, v122
    s_nop 1
    v_cndmask_b32 v122, v122, v123, vcc
    s_movk_i32 s56, 0xe00
    v_mul_u32_u24 v120, s56, v120
    v_mul_u32_u24 v122, s56, v122
    v_lshl_add_u32 v120, v121, 4, v120
    v_lshl_add_u32 v122, v121, 4, v122
    s_lshl_b32 s56, s51, 6
    s_lshl_b32 s57, s51, 1
    s_mul_i32 s58, s57, 9363
    s_lshr_b32 s58, s58, 16
    s_mul_i32 s59, s58, 7
    s_sub_u32 s57, s57, s59
    s_lshl_b32 s58, s58, 4
    s_add_u32 s58, s58, s50
    s_mul_i32 s58, s58, 7
    s_add_u32 s58, s58, s57
    s_lshl_b32 s58, s58, 10
    s_add_u32 s60, s58, 16777216
    s_lshl_b32 s57, s51, 1
    s_add_u32 s57, s57, 1
    s_mul_i32 s58, s57, 9363
    s_lshr_b32 s58, s58, 16
    s_mul_i32 s59, s58, 7
    s_sub_u32 s57, s57, s59
    s_lshl_b32 s58, s58, 4
    s_add_u32 s58, s58, s50
    s_mul_i32 s58, s58, 7
    s_add_u32 s58, s58, s57
    s_lshl_b32 s58, s58, 10
    s_add_u32 s61, s58, 16777216
    s_waitcnt lgkmcnt(0)
    s_mov_b32 s52, s44
    s_and_b32 s53, s45, 0xffff
    s_mov_b32 s54, 1835008
    s_mov_b32 s55, 0x00020000
    s_branch K1_PREPGO
K1_PREP2:
    s_sub_u32 s48, s28, 32
    s_mul_i32 s48, s48, 7
    s_add_u32 s48, s48, s49
    s_lshr_b32 s50, s48, 2
    s_and_b32 s51, s48, 3
    s_lshl_b32 s48, s30, 2
    s_add_u32 s51, s51, s48
    s_lshl_b32 s56, s50, 5
    v_add_u32 v120, s56, v120
    v_lshlrev_b32 v120, 10, v120
    v_lshl_add_u32 v120, v121, 4, v120
    v_add_u32 v122, 0x4000, v120
    s_lshl_b32 s56, s51, 6
    s_lshr_b32 s57, s51, 1
    s_mul_i32 s57, s57, 56
    s_add_u32 s57, s57, s50
    s_lshl_b32 s57, s57, 2
    s_and_b32 s58, s51, 1
    s_lshl_b32 s58, s58, 1
    s_add_u32 s57, s57, s58
    s_lshl_b32 s57, s57, 10
    s_add_u32 s60, s57, 18874368
    s_add_u32 s61, s60, 1024
    s_waitcnt lgkmcnt(0)
    s_mov_b32 s52, s46
    s_and_b32 s53, s47, 0xffff
    s_mov_b32 s54, 1835008
    s_mov_b32 s55, 0x00020000
K1_PREPGO:
    s_lshl_b32 s49, s31, 11
    s_add_u32 s49, s49, 43264
    s_mov_b32 s12, s4
    s_and_b32 s13, s5, 0xffff
    s_mov_b32 s14, 2097152
    s_mov_b32 s15, 0x00020000
    s_mov_b32 s24, s10
    s_and_b32 s25, s11, 0xffff
    s_mov_b32 s26, 20971520
    s_mov_b32 s27, 0x00020000
    s_mov_b32 s16, s68
    s_and_b32 s17, s69, 0xffff
    s_mov_b32 s18, 2097152
    s_mov_b32 s19, 0x00020000
    s_mov_b32 s20, s70
    s_and_b32 s21, s71, 0xffff
    s_mov_b32 s22, 256
    s_mov_b32 s23, 0x00020000
    s_or_b32 s72, s72, 1
    s_lshl_b32 s73, s2, 3
    s_add_u32 s73, s73, s31
    s_cmp_lg_u32 s73, 7
    s_cbranch_scc1 K1_NOTAG
    v_mov_b32 v12, 0
    v_mov_b32 v13, s72
    buffer_store_dword v13, v12, s[20:23], 0 offen sc1
K1_NOTAG:
    buffer_load_dwordx4 v[16:19], v5, s[12:15], s36 offen
    buffer_load_dwordx4 v[20:23], v5, s[12:15], s36 offen offset:256
    buffer_load_dwordx4 v[24:27], v6, s[12:15], s36 offen offset:256
    buffer_load_dwordx4 v[28:31], v6, s[12:15], s36 offen
    v_add_u32 v7, s38, v2
    v_add_u32 v8, s33, v7
    v_cmp_eq_u32 vcc, 0, v8
    v_mov_b32 v8, 0x100
    s_nop 0
    v_cndmask_b32 v7, v7, v8, vcc
    v_cvt_f32_u32 v7, v7
    v_mul_f32 v7, 0x3b000000, v7
    v_cvt_f32_u32 v8, v3
    v_mul_f32 v8, 0x41000000, v8
    s_cmp_eq_u32 s33, 0
    s_cselect_b32 s40, 0, 0x3e800000
    v_mov_b32 v9, s40
    v_fma_f32 v9, v7, v8, v9
    v_add_f32 v10, v9, v7
    v_mul_f32 v8, 0x42000000, v7
    v_cos_f32 v12, v7
    v_cos_f32 v14, v8
    v_cos_f32 v32, v9
    v_cos_f32 v33, v10
    v_add_f32 v9, v9, v8
    v_add_f32 v10, v10, v8
    v_add_f32 v12, v12, v12
    v_add_f32 v14, v14, v14
    v_cos_f32 v40, v9
    v_cos_f32 v41, v10
    v_fma_f32 v34, v12, v33, -v32
    v_fma_f32 v42, v12, v41, -v40
    v_fma_f32 v35, v12, v34, -v33
    v_fma_f32 v43, v12, v42, -v41
    v_fma_f32 v36, v12, v35, -v34
    v_fma_f32 v44, v12, v43, -v42
    v_fma_f32 v37, v12, v36, -v35
    v_fma_f32 v45, v12, v44, -v43
    v_fma_f32 v38, v12, v37, -v36
    v_fma_f32 v46, v12, v45, -v44
    v_fma_f32 v39, v12, v38, -v37
    v_fma_f32 v47, v12, v46, -v45
    v_cvt_pk_bf16_f32 v128, v32, v33
    v_cvt_pk_bf16_f32 v132, v40, v41
    v_cvt_pk_bf16_f32 v129, v34, v35
    v_cvt_pk_bf16_f32 v133, v42, v43
    v_cvt_pk_bf16_f32 v130, v36, v37
    v_cvt_pk_bf16_f32 v134, v44, v45
    v_cvt_pk_bf16_f32 v131, v38, v39
    v_cvt_pk_bf16_f32 v135, v46, v47
    s_mov_b32 m0, s49
    s_nop 0
    buffer_load_dwordx4 v120, s[52:55], s56 offen lds
    s_add_u32 s57, s49, 1024
    s_mov_b32 m0, s57
    s_nop 0
    buffer_load_dwordx4 v122, s[52:55], s56 offen lds
    v_pk_fma_f32 v[32:33], v[40:41], v[14:15], v[32:33] op_sel_hi:[1,0,1] neg_lo:[0,0,1] neg_hi:[0,0,1]
    v_pk_fma_f32 v[34:35], v[42:43], v[14:15], v[34:35] op_sel_hi:[1,0,1] neg_lo:[0,0,1] neg_hi:[0,0,1]
    v_pk_fma_f32 v[36:37], v[44:45], v[14:15], v[36:37] op_sel_hi:[1,0,1] neg_lo:[0,0,1] neg_hi:[0,0,1]
    v_pk_fma_f32 v[38:39], v[46:47], v[14:15], v[38:39] op_sel_hi:[1,0,1] neg_lo:[0,0,1] neg_hi:[0,0,1]
    v_cvt_pk_bf16_f32 v136, v32, v33
    v_cvt_pk_bf16_f32 v137, v34, v35
    v_cvt_pk_bf16_f32 v138, v36, v37
    v_cvt_pk_bf16_f32 v139, v38, v39
    v_pk_fma_f32 v[40:41], v[32:33], v[14:15], v[40:41] op_sel_hi:[1,0,1] neg_lo:[0,0,1] neg_hi:[0,0,1]
    v_pk_fma_f32 v[42:43], v[34:35], v[14:15], v[42:43] op_sel_hi:[1,0,1] neg_lo:[0,0,1] neg_hi:[0,0,1]
    v_pk_fma_f32 v[44:45], v[36:37], v[14:15], v[44:45] op_sel_hi:[1,0,1] neg_lo:[0,0,1] neg_hi:[0,0,1]
    v_pk_fma_f32 v[46:47], v[38:39], v[14:15], v[46:47] op_sel_hi:[1,0,1] neg_lo:[0,0,1] neg_hi:[0,0,1]
    v_cvt_pk_bf16_f32 v140, v40, v41
    v_cvt_pk_bf16_f32 v141, v42, v43
    v_cvt_pk_bf16_f32 v142, v44, v45
    v_cvt_pk_bf16_f32 v143, v46, v47
    v_pk_fma_f32 v[32:33], v[40:41], v[14:15], v[32:33] op_sel_hi:[1,0,1] neg_lo:[0,0,1] neg_hi:[0,0,1]
    v_pk_fma_f32 v[34:35], v[42:43], v[14:15], v[34:35] op_sel_hi:[1,0,1] neg_lo:[0,0,1] neg_hi:[0,0,1]
    v_pk_fma_f32 v[36:37], v[44:45], v[14:15], v[36:37] op_sel_hi:[1,0,1] neg_lo:[0,0,1] neg_hi:[0,0,1]
    v_pk_fma_f32 v[38:39], v[46:47], v[14:15], v[38:39] op_sel_hi:[1,0,1] neg_lo:[0,0,1] neg_hi:[0,0,1]
    v_cvt_pk_bf16_f32 v144, v32, v33
    v_cvt_pk_bf16_f32 v145, v34, v35
    v_cvt_pk_bf16_f32 v146, v36, v37
    v_cvt_pk_bf16_f32 v147, v38, v39
    v_pk_fma_f32 v[40:41], v[32:33], v[14:15], v[40:41] op_sel_hi:[1,0,1] neg_lo:[0,0,1] neg_hi:[0,0,1]
    v_pk_fma_f32 v[42:43], v[34:35], v[14:15], v[42:43] op_sel_hi:[1,0,1] neg_lo:[0,0,1] neg_hi:[0,0,1]
    v_pk_fma_f32 v[44:45], v[36:37], v[14:15], v[44:45] op_sel_hi:[1,0,1] neg_lo:[0,0,1] neg_hi:[0,0,1]
    v_pk_fma_f32 v[46:47], v[38:39], v[14:15], v[46:47] op_sel_hi:[1,0,1] neg_lo:[0,0,1] neg_hi:[0,0,1]
    v_cvt_pk_bf16_f32 v148, v40, v41
    v_cvt_pk_bf16_f32 v149, v42, v43
    v_cvt_pk_bf16_f32 v150, v44, v45
    v_cvt_pk_bf16_f32 v151, v46, v47
    v_pk_fma_f32 v[32:33], v[40:41], v[14:15], v[32:33] op_sel_hi:[1,0,1] neg_lo:[0,0,1] neg_hi:[0,0,1]
    v_pk_fma_f32 v[34:35], v[42:43], v[14:15], v[34:35] op_sel_hi:[1,0,1] neg_lo:[0,0,1] neg_hi:[0,0,1]
    v_pk_fma_f32 v[36:37], v[44:45], v[14:15], v[36:37] op_sel_hi:[1,0,1] neg_lo:[0,0,1] neg_hi:[0,0,1]
    v_pk_fma_f32 v[38:39], v[46:47], v[14:15], v[38:39] op_sel_hi:[1,0,1] neg_lo:[0,0,1] neg_hi:[0,0,1]
    v_cvt_pk_bf16_f32 v152, v32, v33
    v_cvt_pk_bf16_f32 v153, v34, v35
    v_cvt_pk_bf16_f32 v154, v36, v37
    v_cvt_pk_bf16_f32 v155, v38, v39
    v_pk_fma_f32 v[40:41], v[32:33], v[14:15], v[40:41] op_sel_hi:[1,0,1] neg_lo:[0,0,1] neg_hi:[0,0,1]
    v_pk_fma_f32 v[42:43], v[34:35], v[14:15], v[42:43] op_sel_hi:[1,0,1] neg_lo:[0,0,1] neg_hi:[0,0,1]
    v_pk_fma_f32 v[44:45], v[36:37], v[14:15], v[44:45] op_sel_hi:[1,0,1] neg_lo:[0,0,1] neg_hi:[0,0,1]
    v_pk_fma_f32 v[46:47], v[38:39], v[14:15], v[46:47] op_sel_hi:[1,0,1] neg_lo:[0,0,1] neg_hi:[0,0,1]
    v_cvt_pk_bf16_f32 v156, v40, v41
    v_cvt_pk_bf16_f32 v157, v42, v43
    v_cvt_pk_bf16_f32 v158, v44, v45
    v_cvt_pk_bf16_f32 v159, v46, v47
    s_lshl_b32 s40, s33, 4
    v_add_u32 v7, s40, v2
    v_lshl_add_u32 v8, v3, 9, s28
    v_mul_u32_u24 v9, v7, v8
    v_cvt_f32_u32 v9, v9
    v_mul_f32 v9, 0x3a000000, v9
    v_cvt_f32_u32 v8, v7
    v_mul_f32 v8, 0x3d000000, v8
    v_add_f32 v10, v9, v8
    v_add_f32 v8, v8, v8
    v_cos_f32 v12, v9
    v_cos_f32 v13, v10
    v_sin_f32 v14, v9
    v_sin_f32 v15, v10
    v_add_f32 v9, v9, v8
    v_add_f32 v10, v10, v8
    v_cvt_pk_bf16_f32 v96, v12, v13
    v_cvt_pk_bf16_f32 v100, v14, v15
    v_xor_b32 v104, 0x80008000, v100
    v_cos_f32 v12, v9
    v_cos_f32 v13, v10
    v_sin_f32 v14, v9
    v_sin_f32 v15, v10
    v_add_f32 v9, v9, v8
    v_add_f32 v10, v10, v8
    v_cvt_pk_bf16_f32 v97, v12, v13
    v_cvt_pk_bf16_f32 v101, v14, v15
    v_xor_b32 v105, 0x80008000, v101
    v_cos_f32 v12, v9
    v_cos_f32 v13, v10
    v_sin_f32 v14, v9
    v_sin_f32 v15, v10
    v_add_f32 v9, v9, v8
    v_add_f32 v10, v10, v8
    v_cvt_pk_bf16_f32 v98, v12, v13
    v_cvt_pk_bf16_f32 v102, v14, v15
    v_xor_b32 v106, 0x80008000, v102
    v_cos_f32 v12, v9
    v_cos_f32 v13, v10
    v_sin_f32 v14, v9
    v_sin_f32 v15, v10
    v_add_f32 v9, v9, v8
    v_add_f32 v10, v10, v8
    v_cvt_pk_bf16_f32 v99, v12, v13
    v_cvt_pk_bf16_f32 v103, v14, v15
    v_xor_b32 v107, 0x80008000, v103
    s_and_b32 s40, s31, 1
    s_lshl_b32 s40, s40, 4
    s_lshr_b32 s41, s31, 1
    s_lshl_b32 s41, s41, 2
    s_add_u32 s40, s40, s41
    v_add_u32 v8, s40, v3
    v_mul_u32_u24 v8, 544, v8
    v_lshl_add_u32 v8, v2, 4, v8
    v_mul_u32_u24 v9, 544, v2
    v_lshl_add_u32 v9, v3, 4, v9
    s_mul_i32 s40, s33, 17408
    v_add_u32 v9, s40, v9
    v_and_b32 v12, 1, v2
    v_lshlrev_b32 v12, 31, v12
    v_or_b32 v108, 1.0, v12
    s_cmp_eq_u32 s33, 0
    s_cselect_b32 s40, 1.0, 0
    v_mul_f32 v108, s40, v108
    s_lshl_b32 s40, s31, 4
    v_lshl_add_u32 v109, v3, 2, s40
    v_lshlrev_b32 v110, 5, v3
    s_lshl_b32 s40, s31, 10
    s_add_u32 s40, s40, 35072
    v_lshl_add_u32 v10, v1, 4, s40
    s_lshl_b32 s40, s32, 10
    s_add_u32 s40, s40, 35072
    v_lshl_add_u32 v11, v1, 4, s40
    v_lshlrev_b32 v111, 16, v7
    v_lshl_add_u32 v111, v3, 4, v111
    s_lshl_b32 s39, s28, 10
    s_lshl_b32 s40, s38, 2
    s_add_u32 s39, s39, s40
    v_mov_b32 v4, 0x3f803f80
    s_mov_b32 s41, 0xffff0000
    s_waitcnt vmcnt(2)
    v_dot2_f32_bf16 v12, v16, v4, 0
    v_dot2_f32_bf16 v14, v16, v16, 0
    v_dot2_f32_bf16 v13, v17, v4, 0
    v_dot2_f32_bf16 v15, v17, v17, 0
    v_dot2_f32_bf16 v12, v18, v4, v12
    v_dot2_f32_bf16 v14, v18, v18, v14
    v_dot2_f32_bf16 v13, v19, v4, v13
    v_dot2_f32_bf16 v15, v19, v19, v15
    v_dot2_f32_bf16 v12, v20, v4, v12
    v_dot2_f32_bf16 v14, v20, v20, v14
    v_dot2_f32_bf16 v13, v21, v4, v13
    v_dot2_f32_bf16 v15, v21, v21, v15
    v_dot2_f32_bf16 v12, v22, v4, v12
    v_dot2_f32_bf16 v14, v22, v22, v14
    v_dot2_f32_bf16 v13, v23, v4, v13
    v_dot2_f32_bf16 v15, v23, v23, v15
    v_dot2_f32_bf16 v12, v24, v4, v12
    v_dot2_f32_bf16 v14, v24, v24, v14
    v_dot2_f32_bf16 v13, v25, v4, v13
    v_dot2_f32_bf16 v15, v25, v25, v15
    v_dot2_f32_bf16 v12, v26, v4, v12
    v_dot2_f32_bf16 v14, v26, v26, v14
    v_dot2_f32_bf16 v13, v27, v4, v13
    v_dot2_f32_bf16 v15, v27, v27, v15
    v_dot2_f32_bf16 v12, v28, v4, v12
    v_dot2_f32_bf16 v14, v28, v28, v14
    v_dot2_f32_bf16 v13, v29, v4, v13
    v_dot2_f32_bf16 v15, v29, v29, v15
    v_dot2_f32_bf16 v12, v30, v4, v12
    v_dot2_f32_bf16 v14, v30, v30, v14
    v_dot2_f32_bf16 v13, v31, v4, v13
    v_dot2_f32_bf16 v15, v31, v31, v15
    v_lshlrev_b32 v32, 16, v16
    v_and_b32 v33, s41, v16
    v_lshlrev_b32 v34, 16, v17
    v_add_f32 v12, v12, v13
    v_add_f32 v14, v14, v15
    v_and_b32 v35, s41, v17
    v_add_f32_dpp v12, v12, v12 quad_perm:[1,0,3,2] row_mask:0xf bank_mask:0xf
    v_add_f32_dpp v14, v14, v14 quad_perm:[1,0,3,2] row_mask:0xf bank_mask:0xf
    v_lshlrev_b32 v36, 16, v18
    v_and_b32 v37, s41, v18
    v_add_f32_dpp v12, v12, v12 quad_perm:[2,3,0,1] row_mask:0xf bank_mask:0xf
    v_add_f32_dpp v14, v14, v14 quad_perm:[2,3,0,1] row_mask:0xf bank_mask:0xf
    v_lshlrev_b32 v38, 16, v19
    v_and_b32 v39, s41, v19
    v_add_f32_dpp v12, v12, v12 row_half_mirror row_mask:0xf bank_mask:0xf
    v_add_f32_dpp v14, v14, v14 row_half_mirror row_mask:0xf bank_mask:0xf
    v_lshlrev_b32 v48, 16, v20
    v_and_b32 v49, s41, v20
    v_add_f32_dpp v12, v12, v12 row_mirror row_mask:0xf bank_mask:0xf
    v_add_f32_dpp v14, v14, v14 row_mirror row_mask:0xf bank_mask:0xf
    v_lshlrev_b32 v50, 16, v21
    s_mov_b32 s40, 0x3b000000
    v_mul_f32 v12, s40, v12
    v_mul_f32 v14, s40, v14
    v_fma_f32 v14, -v12, v12, v14
    v_max_f32 v14, 0, v14
    v_add_f32 v14, 0x3727c5ac, v14
    v_rsq_f32 v14, v14
    v_and_b32 v51, s41, v21
    v_lshlrev_b32 v52, 16, v22
    v_and_b32 v53, s41, v22
    v_lshlrev_b32 v54, 16, v23
    v_and_b32 v55, s41, v23
    v_lshlrev_b32 v64, 16, v24
    v_and_b32 v47, s41, v24
    v_lshlrev_b32 v46, 16, v25
    v_and_b32 v45, s41, v25
    v_lshlrev_b32 v44, 16, v26
    v_and_b32 v43, s41, v26
    v_lshlrev_b32 v42, 16, v27
    v_and_b32 v41, s41, v27
    v_lshlrev_b32 v65, 16, v28
    v_and_b32 v63, s41, v28
    v_lshlrev_b32 v62, 16, v29
    v_and_b32 v61, s41, v29
    v_lshlrev_b32 v60, 16, v30
    v_and_b32 v59, s41, v30
    v_lshlrev_b32 v58, 16, v31
    v_and_b32 v57, s41, v31
    v_cmp_eq_u32 vcc, 0, v2
    v_mul_f32 v13, -2.0, v12
    v_mov_b32_dpp v66, v64 row_ror:1 row_mask:0xf bank_mask:0xf
    v_mov_b32_dpp v67, v65 row_ror:1 row_mask:0xf bank_mask:0xf
    v_mul_f32 v68, v13, v14
    v_cndmask_b32 v40, v66, v12, vcc
    v_cndmask_b32 v56, v67, v66, vcc
    v_sub_f32 v67, v67, v12
    v_mul_f32 v67, v67, v14
    v_pk_add_f32 v[88:89], v[32:33], v[40:41]
    v_pk_add_f32 v[90:91], v[32:33], v[40:41] neg_lo:[0,1] neg_hi:[0,1]
    v_pk_fma_f32 v[88:89], v[88:89], v[14:15], v[68:69] op_sel_hi:[1,0,0]
    v_pk_mul_f32 v[90:91], v[90:91], v[14:15] op_sel_hi:[1,0]
    v_cvt_pk_bf16_f32 v72, v88, v89
    v_cvt_pk_bf16_f32 v80, v90, v91
    v_pk_add_f32 v[92:93], v[34:35], v[42:43]
    v_pk_add_f32 v[94:95], v[34:35], v[42:43] neg_lo:[0,1] neg_hi:[0,1]
    v_pk_fma_f32 v[92:93], v[92:93], v[14:15], v[68:69] op_sel_hi:[1,0,0]
    v_pk_mul_f32 v[94:95], v[94:95], v[14:15] op_sel_hi:[1,0]
    v_cvt_pk_bf16_f32 v73, v92, v93
    v_cvt_pk_bf16_f32 v81, v94, v95
    v_pk_add_f32 v[88:89], v[36:37], v[44:45]
    v_pk_add_f32 v[90:91], v[36:37], v[44:45] neg_lo:[0,1] neg_hi:[0,1]
    v_pk_fma_f32 v[88:89], v[88:89], v[14:15], v[68:69] op_sel_hi:[1,0,0]
    v_pk_mul_f32 v[90:91], v[90:91], v[14:15] op_sel_hi:[1,0]
    v_cvt_pk_bf16_f32 v74, v88, v89
    v_cvt_pk_bf16_f32 v82, v90, v91
    v_pk_add_f32 v[92:93], v[38:39], v[46:47]
    v_pk_add_f32 v[94:95], v[38:39], v[46:47] neg_lo:[0,1] neg_hi:[0,1]
    v_pk_fma_f32 v[92:93], v[92:93], v[14:15], v[68:69] op_sel_hi:[1,0,0]
    v_pk_mul_f32 v[94:95], v[94:95], v[14:15] op_sel_hi:[1,0]
    v_cvt_pk_bf16_f32 v75, v92, v93
    v_cvt_pk_bf16_f32 v83, v94, v95
    ds_write_b128 v8, v[72:75] offset:0
    ds_write_b128 v8, v[80:83] offset:17408
    v_pk_add_f32 v[88:89], v[48:49], v[56:57]
    v_pk_add_f32 v[90:91], v[48:49], v[56:57] neg_lo:[0,1] neg_hi:[0,1]
    v_pk_fma_f32 v[88:89], v[88:89], v[14:15], v[68:69] op_sel_hi:[1,0,0]
    v_pk_mul_f32 v[90:91], v[90:91], v[14:15] op_sel_hi:[1,0]
    v_cvt_pk_bf16_f32 v76, v88, v89
    v_cvt_pk_bf16_f32 v84, v90, v91
    v_pk_add_f32 v[92:93], v[50:51], v[58:59]
    v_pk_add_f32 v[94:95], v[50:51], v[58:59] neg_lo:[0,1] neg_hi:[0,1]
    v_pk_fma_f32 v[92:93], v[92:93], v[14:15], v[68:69] op_sel_hi:[1,0,0]
    v_pk_mul_f32 v[94:95], v[94:95], v[14:15] op_sel_hi:[1,0]
    v_cvt_pk_bf16_f32 v77, v92, v93
    v_cvt_pk_bf16_f32 v85, v94, v95
    v_pk_add_f32 v[88:89], v[52:53], v[60:61]
    v_pk_add_f32 v[90:91], v[52:53], v[60:61] neg_lo:[0,1] neg_hi:[0,1]
    v_pk_fma_f32 v[88:89], v[88:89], v[14:15], v[68:69] op_sel_hi:[1,0,0]
    v_pk_mul_f32 v[90:91], v[90:91], v[14:15] op_sel_hi:[1,0]
    v_cvt_pk_bf16_f32 v78, v88, v89
    v_cvt_pk_bf16_f32 v86, v90, v91
    v_pk_add_f32 v[92:93], v[54:55], v[62:63]
    v_pk_add_f32 v[94:95], v[54:55], v[62:63] neg_lo:[0,1] neg_hi:[0,1]
    v_pk_fma_f32 v[92:93], v[92:93], v[14:15], v[68:69] op_sel_hi:[1,0,0]
    v_pk_mul_f32 v[94:95], v[94:95], v[14:15] op_sel_hi:[1,0]
    v_cvt_pk_bf16_f32 v79, v92, v93
    v_cvt_pk_bf16_f32 v87, v94, v95
    ds_write_b128 v8, v[76:79] offset:256
    ds_write_b128 v8, v[84:87] offset:17664
    s_and_saveexec_b64 s[42:43], vcc
    ds_write_b32 v109, v67 offset:34816
    s_mov_b64 exec, s[42:43]
    s_cmp_eq_u32 s31, 7
    s_cbranch_scc1 K1_PDONE
    v_lshrrev_b32 v12, 2, v2
    v_lshl_add_u32 v12, v3, 3, v12
    v_lshlrev_b32 v12, 6, v12
    v_and_b32 v13, 3, v1
    v_lshl_add_u32 v12, v13, 3, v12
    v_add_u32 v12, s49, v12
    v_lshlrev_b32 v13, 4, v1
    s_waitcnt vmcnt(0)
    ds_read_b64_tr_b16 v[160:161], v12 offset:0
    ds_read_b64_tr_b16 v[162:163], v12 offset:256
    ds_read_b64_tr_b16 v[164:165], v12 offset:32
    ds_read_b64_tr_b16 v[166:167], v12 offset:288
    s_waitcnt lgkmcnt(0)
    buffer_store_dwordx4 v[160:163], v13, s[24:27], s60 offen sc1
    buffer_store_dwordx4 v[164:167], v13, s[24:27], s61 offen sc1
    s_cmp_ge_u32 s28, 32
    s_cbranch_scc1 K1_PDONE
    v_mov_b32 v24, 0x3f803f80
    v_dot2_f32_bf16 v168, v160, v24, 0
    v_dot2_f32_bf16 v169, v164, v24, 0
    v_dot2_f32_bf16 v168, v161, v24, v168
    v_dot2_f32_bf16 v169, v165, v24, v169
    v_dot2_f32_bf16 v168, v162, v24, v168
    v_dot2_f32_bf16 v169, v166, v24, v169
    v_dot2_f32_bf16 v168, v163, v24, v168
    v_dot2_f32_bf16 v169, v167, v24, v169
    s_nop 2
    v_permlane32_swap_b32 v168, v169
    v_add_f32 v168, v168, v169
    v_mov_b32 v169, v168
    s_nop 1
    v_permlane16_swap_b32 v168, v169
    v_add_f32 v168, v168, v169
    v_lshrrev_b32 v12, 5, v1
    v_lshl_add_u32 v12, v12, 4, v2
    v_lshlrev_b32 v12, 2, v12
    s_mul_i32 s56, s50, 7168
    s_lshl_b32 s57, s51, 7
    s_add_u32 s56, s56, s57
    s_add_u32 s56, s56, 3145728
    buffer_store_dword v168, v12, s[24:27], s56 offen sc1
K1_PDONE:
    s_waitcnt lgkmcnt(0)
    s_barrier
    v_mov_b32 v125, 0
    buffer_load_dword v126, v125, s[20:23], 0 offen sc1
    ds_read_b128 v[112:115], v110 offset:34816
    ds_read_b128 v[116:119], v110 offset:34832
    ds_read_b128 v[16:19], v9 offset:0
    ds_read_b128 v[20:23], v9 offset:8704
    ds_read_b128 v[24:27], v9 offset:64
    ds_read_b128 v[28:31], v9 offset:8768
    ds_read_b128 v[32:35], v9 offset:128
    ds_read_b128 v[36:39], v9 offset:8832
    ds_read_b128 v[40:43], v9 offset:192
    ds_read_b128 v[44:47], v9 offset:8896
    ds_read_b128 v[48:51], v9 offset:256
    ds_read_b128 v[52:55], v9 offset:8960
    ds_read_b128 v[56:59], v9 offset:320
    ds_read_b128 v[60:63], v9 offset:9024
    s_waitcnt lgkmcnt(12)
    v_mul_f32 v112, v108, v112
    v_mul_f32 v113, v108, v113
    v_mul_f32 v114, v108, v114
    v_mul_f32 v115, v108, v115
    v_mul_f32 v116, v108, v116
    v_mul_f32 v117, v108, v117
    v_mul_f32 v118, v108, v118
    v_mul_f32 v119, v108, v119
    ds_read_b128 v[64:67], v9 offset:384
    ds_read_b128 v[68:71], v9 offset:9088
    s_waitcnt lgkmcnt(12)
    v_mfma_f32_16x16x32_bf16 v[112:115], v[16:19], v[128:131], v[112:115]
    v_mfma_f32_16x16x32_bf16 v[116:119], v[20:23], v[128:131], v[116:119]
    ds_read_b128 v[72:75], v9 offset:448
    ds_read_b128 v[76:79], v9 offset:9152
    s_waitcnt lgkmcnt(12)
    v_mfma_f32_16x16x32_bf16 v[112:115], v[24:27], v[132:135], v[112:115]
    v_mfma_f32_16x16x32_bf16 v[116:119], v[28:31], v[132:135], v[116:119]
    s_waitcnt lgkmcnt(10)
    v_mfma_f32_16x16x32_bf16 v[112:115], v[32:35], v[136:139], v[112:115]
    v_mfma_f32_16x16x32_bf16 v[116:119], v[36:39], v[136:139], v[116:119]
    s_waitcnt lgkmcnt(8)
    v_mfma_f32_16x16x32_bf16 v[112:115], v[40:43], v[140:143], v[112:115]
    v_mfma_f32_16x16x32_bf16 v[116:119], v[44:47], v[140:143], v[116:119]
    s_waitcnt lgkmcnt(6)
    v_mfma_f32_16x16x32_bf16 v[112:115], v[48:51], v[144:147], v[112:115]
    v_mfma_f32_16x16x32_bf16 v[116:119], v[52:55], v[144:147], v[116:119]
    s_waitcnt lgkmcnt(4)
    v_mfma_f32_16x16x32_bf16 v[112:115], v[56:59], v[148:151], v[112:115]
    v_mfma_f32_16x16x32_bf16 v[116:119], v[60:63], v[148:151], v[116:119]
    s_waitcnt lgkmcnt(2)
    v_mfma_f32_16x16x32_bf16 v[112:115], v[64:67], v[152:155], v[112:115]
    v_mfma_f32_16x16x32_bf16 v[116:119], v[68:71], v[152:155], v[116:119]
    s_waitcnt lgkmcnt(0)
    v_mfma_f32_16x16x32_bf16 v[112:115], v[72:75], v[156:159], v[112:115]
    v_mfma_f32_16x16x32_bf16 v[116:119], v[76:79], v[156:159], v[116:119]
    s_nop 6
    v_cvt_pk_bf16_f32 v80, v112, v113
    v_cvt_pk_bf16_f32 v81, v114, v115
    v_cvt_pk_bf16_f32 v82, v116, v117
    v_cvt_pk_bf16_f32 v83, v118, v119
    ds_write_b128 v10, v[80:83]
    s_waitcnt lgkmcnt(0)
    s_barrier
    ds_read_b128 v[68:71], v11
    ds_read_b128 v[72:75], v11 offset:4096
    s_waitcnt lgkmcnt(1)
    v_mfma_f32_16x16x32_bf16 v[76:79], v[68:71], v[96:99], 0
    v_mfma_f32_16x16x32_bf16 v[84:87], v[68:71], v[104:107], 0
    s_waitcnt lgkmcnt(0)
    v_mfma_f32_16x16x32_bf16 v[76:79], v[72:75], v[100:103], v[76:79]
    v_mfma_f32_16x16x32_bf16 v[84:87], v[72:75], v[96:99], v[84:87]
    s_nop 6
    v_cvt_pk_bf16_f32 v88, v76, v77
    v_cvt_pk_bf16_f32 v89, v78, v79
    v_cvt_pk_bf16_f32 v90, v84, v85
    v_cvt_pk_bf16_f32 v91, v86, v87
    buffer_store_dwordx4 v[88:91], v111, s[24:27], s39 offen sc1
K1_END:
    s_waitcnt vmcnt(0) lgkmcnt(0)
    s_barrier
    v_lshlrev_b32 v4, 4, v1
    s_cmp_lt_u32 s31, 4
    s_cbranch_scc1 KC_COMPUTE
    s_sub_u32 s33, s31, 4
    s_and_b32 s61, s2, 7
    s_lshr_b32 s29, s2, 3
    s_lshr_b32 s60, s61, 1
    s_lshl_b32 s60, s60, 2
    s_and_b32 s3, s29, 3
    s_add_u32 s60, s60, s3
    s_lshl_b32 s50, s61, 2
    s_add_u32 s50, s50, s3
    s_and_b32 s61, s61, 1
    s_lshl_b32 s61, s61, 3
    s_lshr_b32 s29, s29, 2
    s_add_u32 s61, s61, s29
    s_mul_i32 s62, s33, 7168
    s_mul_i32 s63, s61, 114688
    s_add_u32 s63, s63, s62
    s_add_u32 s63, s63, 16777216
    s_mul_i32 s52, s29, 229376
    s_mul_i32 s53, s33, 57344
    s_add_u32 s52, s52, s53
    s_add_u32 s52, s52, 18874368
    s_mov_b32 s67, s52
    s_lshl_b32 s53, s33, 12
    s_cmp_lg_u32 s31, 4
    s_cbranch_scc1 KH2_WAITED
    s_lshl_b32 s36, s30, 6
    s_add_u32 s36, s36, s28
    s_lshl_b32 s36, s36, 7
    s_add_u32 s36, s36, 3735552
    v_mov_b32 v8, 0
    v_mov_b32 v9, v126
    s_mov_b32 s55, 0
KH_TAGPOLL:
    s_nop 1
    v_readfirstlane_b32 s72, v9
    s_add_u32 s55, s55, 1
    s_nop 2
    s_cmp_lg_u32 s72, 0
    s_cbranch_scc1 KH_TAGGED
    buffer_load_dword v9, v8, s[20:23], 0 offen sc1
    s_waitcnt vmcnt(0)
    s_cmp_lt_u32 s55, 0x40000
    s_cbranch_scc1 KH_TAGPOLL
KH_TAGGED:
    buffer_store_dword v9, v8, s[24:27], s36 offen sc1
    s_lshr_b32 s46, s2, 6
    s_lshl_b32 s46, s46, 13
    s_add_u32 s46, s46, 3735552
    v_lshlrev_b32 v13, 7, v1
    s_mov_b32 s55, 0
KH2_POLL:
    buffer_load_dword v24, v13, s[24:27], s46 offen sc1
    s_waitcnt vmcnt(0)
    v_cmp_ne_u32 s[58:59], s72, v24
    s_add_u32 s55, s55, 1
    s_nop 2
    s_cmp_eq_u64 s[58:59], 0
    s_cbranch_scc1 KH2_DONE
    s_mov_b64 exec, s[58:59]
    s_sleep 1
    s_cmp_lt_u32 s55, 0x40000
    s_cbranch_scc1 KH2_POLL
KH2_DONE:
    s_mov_b64 exec, -1
KH2_WAITED:
    s_barrier
    s_mov_b32 m0, s62
    s_nop 0
    buffer_load_dwordx4 v4, s[24:27], s63 offen offset:0 sc1 lds
    buffer_load_dwordx4 v4, s[24:27], s63 offen offset:1024 sc1 lds
    buffer_load_dwordx4 v4, s[24:27], s63 offen offset:2048 sc1 lds
    buffer_load_dwordx4 v4, s[24:27], s63 offen offset:3072 sc1 lds
    s_add_u32 s64, s62, 4096
    s_add_u32 s65, s63, 4096
    s_mov_b32 m0, s64
    s_nop 0
    buffer_load_dwordx4 v4, s[24:27], s65 offen offset:0 sc1 lds
    buffer_load_dwordx4 v4, s[24:27], s65 offen offset:1024 sc1 lds
    buffer_load_dwordx4 v4, s[24:27], s65 offen offset:2048 sc1 lds
    s_add_u32 s62, s62, 28672
    s_add_u32 s63, s63, 28672
    s_and_b32 s36, s2, 31
    s_lshl_b32 s36, s36, 3
    s_lshr_b32 s37, s2, 5
    s_add_u32 s36, s36, s37
    s_lshl_b32 s36, s36, 7
    s_add_u32 s36, s36, 3670016
    v_bfe_u32 v11, v1, 3, 1
    s_lshl_b32 s37, s60, 1
    v_add_u32 v11, s37, v11
    v_sub_u32 v12, 32, v11
    v_and_b32 v12, 31, v12
    v_and_b32 v13, 16, v1
    v_cmp_ne_u32 vcc, 0, v13
    s_nop 1
    v_cndmask_b32 v11, v11, v12, vcc
    v_and_b32 v12, 7, v1
    v_lshl_add_u32 v11, v11, 3, v12
    v_lshlrev_b32 v11, 7, v11
    s_mov_b32 s46, 3670016
    s_barrier
    s_mov_b32 m0, s62
    s_nop 0
    buffer_load_dwordx4 v4, s[24:27], s63 offen offset:0 sc1 lds
    buffer_load_dwordx4 v4, s[24:27], s63 offen offset:1024 sc1 lds
    buffer_load_dwordx4 v4, s[24:27], s63 offen offset:2048 sc1 lds
    buffer_load_dwordx4 v4, s[24:27], s63 offen offset:3072 sc1 lds
    s_add_u32 s64, s62, 4096
    s_add_u32 s65, s63, 4096
    s_mov_b32 m0, s64
    s_nop 0
    buffer_load_dwordx4 v4, s[24:27], s65 offen offset:0 sc1 lds
    buffer_load_dwordx4 v4, s[24:27], s65 offen offset:1024 sc1 lds
    buffer_load_dwordx4 v4, s[24:27], s65 offen offset:2048 sc1 lds
    s_add_u32 s62, s62, 28672
    s_add_u32 s63, s63, 28672
    s_mov_b32 m0, s62
    s_nop 0
    buffer_load_dwordx4 v4, s[24:27], s63 offen offset:0 sc1 lds
    buffer_load_dwordx4 v4, s[24:27], s63 offen offset:1024 sc1 lds
    buffer_load_dwordx4 v4, s[24:27], s63 offen offset:2048 sc1 lds
    buffer_load_dwordx4 v4, s[24:27], s63 offen offset:3072 sc1 lds
    s_add_u32 s64, s62, 4096
    s_add_u32 s65, s63, 4096
    s_mov_b32 m0, s64
    s_nop 0
    buffer_load_dwordx4 v4, s[24:27], s65 offen offset:0 sc1 lds
    buffer_load_dwordx4 v4, s[24:27], s65 offen offset:1024 sc1 lds
    buffer_load_dwordx4 v4, s[24:27], s65 offen offset:2048 sc1 lds
    s_add_u32 s62, s62, 28672
    s_add_u32 s63, s63, 28672
    s_barrier
    s_cmp_lg_u32 s31, 4
    s_cbranch_scc1 KH_NOPUB2
    buffer_store_dword v9, v8, s[24:27], s36 offen sc1
KH_NOPUB2:
    s_mov_b32 m0, s62
    s_nop 0
    buffer_load_dwordx4 v4, s[24:27], s63 offen offset:0 sc1 lds
    buffer_load_dwordx4 v4, s[24:27], s63 offen offset:1024 sc1 lds
    buffer_load_dwordx4 v4, s[24:27], s63 offen offset:2048 sc1 lds
    buffer_load_dwordx4 v4, s[24:27], s63 offen offset:3072 sc1 lds
    s_add_u32 s64, s62, 4096
    s_add_u32 s65, s63, 4096
    s_mov_b32 m0, s64
    s_nop 0
    buffer_load_dwordx4 v4, s[24:27], s65 offen offset:0 sc1 lds
    buffer_load_dwordx4 v4, s[24:27], s65 offen offset:1024 sc1 lds
    buffer_load_dwordx4 v4, s[24:27], s65 offen offset:2048 sc1 lds
    s_add_u32 s62, s62, 28672
    s_add_u32 s63, s63, 28672
    s_cmp_lg_u32 s31, 4
    s_cbranch_scc1 KH3_WAITED
    s_mov_b32 s55, 0
KH3_POLL:
    buffer_load_dword v24, v11, s[24:27], s46 offen sc1
    s_waitcnt vmcnt(0)
    v_cmp_ne_u32 s[58:59], s72, v24
    s_add_u32 s55, s55, 1
    s_nop 2
    s_cmp_eq_u64 s[58:59], 0
    s_cbranch_scc1 KH3_DONE
    s_mov_b64 exec, s[58:59]
    s_sleep 1
    s_cmp_lt_u32 s55, 0x40000
    s_cbranch_scc1 KH3_POLL
KH3_DONE:
    s_mov_b64 exec, -1
KH3_WAITED:
    s_waitcnt vmcnt(0)
    s_barrier
    s_lshl_b32 s36, s60, 4
    s_add_u32 s36, s36, s61
    s_lshl_b32 s36, s36, 7
    s_add_u32 s36, s36, 3702784
    s_lshr_b32 s46, s50, 1
    s_lshl_b32 s46, s46, 11
    s_add_u32 s46, s46, 3702784
    v_lshlrev_b32 v11, 7, v2
    s_add_u32 s54, s53, 114688
    s_mov_b32 m0, s54
    s_nop 0
    buffer_load_dwordx4 v4, s[24:27], s52 offen offset:0 sc1 lds
    buffer_load_dwordx4 v4, s[24:27], s52 offen offset:1024 sc1 lds
    buffer_load_dwordx4 v4, s[24:27], s52 offen offset:2048 sc1 lds
    buffer_load_dwordx4 v4, s[24:27], s52 offen offset:3072 sc1 lds
    s_add_u32 s52, s52, 4096
    s_add_u32 s54, s53, 131072
    s_mov_b32 m0, s54
    s_nop 0
    buffer_load_dwordx4 v4, s[24:27], s52 offen offset:0 sc1 lds
    buffer_load_dwordx4 v4, s[24:27], s52 offen offset:1024 sc1 lds
    buffer_load_dwordx4 v4, s[24:27], s52 offen offset:2048 sc1 lds
    buffer_load_dwordx4 v4, s[24:27], s52 offen offset:3072 sc1 lds
    s_add_u32 s52, s52, 4096
    s_barrier
    s_add_u32 s54, s53, 0
    s_mov_b32 m0, s54
    s_nop 0
    buffer_load_dwordx4 v4, s[24:27], s52 offen offset:0 sc1 lds
    buffer_load_dwordx4 v4, s[24:27], s52 offen offset:1024 sc1 lds
    buffer_load_dwordx4 v4, s[24:27], s52 offen offset:2048 sc1 lds
    buffer_load_dwordx4 v4, s[24:27], s52 offen offset:3072 sc1 lds
    s_add_u32 s52, s52, 4096
    s_add_u32 s54, s53, 16384
    s_mov_b32 m0, s54
    s_nop 0
    buffer_load_dwordx4 v4, s[24:27], s52 offen offset:0 sc1 lds
    buffer_load_dwordx4 v4, s[24:27], s52 offen offset:1024 sc1 lds
    buffer_load_dwordx4 v4, s[24:27], s52 offen offset:2048 sc1 lds
    buffer_load_dwordx4 v4, s[24:27], s52 offen offset:3072 sc1 lds
    s_add_u32 s52, s52, 4096
    s_add_u32 s54, s53, 32768
    s_mov_b32 m0, s54
    s_nop 0
    buffer_load_dwordx4 v4, s[24:27], s52 offen offset:0 sc1 lds
    buffer_load_dwordx4 v4, s[24:27], s52 offen offset:1024 sc1 lds
    buffer_load_dwordx4 v4, s[24:27], s52 offen offset:2048 sc1 lds
    buffer_load_dwordx4 v4, s[24:27], s52 offen offset:3072 sc1 lds
    s_add_u32 s52, s52, 4096
    s_barrier
    s_add_u32 s54, s53, 49152
    s_mov_b32 m0, s54
    s_nop 0
    buffer_load_dwordx4 v4, s[24:27], s52 offen offset:0 sc1 lds
    buffer_load_dwordx4 v4, s[24:27], s52 offen offset:1024 sc1 lds
    buffer_load_dwordx4 v4, s[24:27], s52 offen offset:2048 sc1 lds
    buffer_load_dwordx4 v4, s[24:27], s52 offen offset:3072 sc1 lds
    s_add_u32 s52, s52, 4096
    s_add_u32 s54, s53, 65536
    s_mov_b32 m0, s54
    s_nop 0
    buffer_load_dwordx4 v4, s[24:27], s52 offen offset:0 sc1 lds
    buffer_load_dwordx4 v4, s[24:27], s52 offen offset:1024 sc1 lds
    buffer_load_dwordx4 v4, s[24:27], s52 offen offset:2048 sc1 lds
    buffer_load_dwordx4 v4, s[24:27], s52 offen offset:3072 sc1 lds
    s_add_u32 s52, s52, 4096
    s_add_u32 s57, s67, 36864
    s_sub_u32 s56, s57, 57344
    s_cmp_eq_u32 s31, 4
    s_cbranch_scc1 KH_HVDONE
    buffer_load_dwordx4 v[32:35], v4, s[24:27], s57 offen offset:0 sc1
    buffer_load_dwordx4 v[36:39], v4, s[24:27], s57 offen offset:1024 sc1
    buffer_load_dwordx4 v[40:43], v4, s[24:27], s57 offen offset:2048 sc1
    buffer_load_dwordx4 v[44:47], v4, s[24:27], s57 offen offset:3072 sc1
    s_add_u32 s57, s57, 4096
    buffer_load_dwordx4 v[48:51], v4, s[24:27], s57 offen offset:0 sc1
    buffer_load_dwordx4 v[52:55], v4, s[24:27], s57 offen offset:1024 sc1
    buffer_load_dwordx4 v[56:59], v4, s[24:27], s57 offen offset:2048 sc1
    buffer_load_dwordx4 v[60:63], v4, s[24:27], s57 offen offset:3072 sc1
    s_add_u32 s57, s57, 4096
    buffer_load_dwordx4 v[64:67], v4, s[24:27], s57 offen offset:0 sc1
    buffer_load_dwordx4 v[68:71], v4, s[24:27], s57 offen offset:1024 sc1
    buffer_load_dwordx4 v[72:75], v4, s[24:27], s57 offen offset:2048 sc1
    buffer_load_dwordx4 v[76:79], v4, s[24:27], s57 offen offset:3072 sc1
    s_add_u32 s57, s57, 4096
    buffer_load_dwordx4 v[80:83], v4, s[24:27], s57 offen offset:0 sc1
    buffer_load_dwordx4 v[84:87], v4, s[24:27], s57 offen offset:1024 sc1
    buffer_load_dwordx4 v[88:91], v4, s[24:27], s57 offen offset:2048 sc1
    buffer_load_dwordx4 v[92:95], v4, s[24:27], s57 offen offset:3072 sc1
    s_add_u32 s57, s57, 4096
    buffer_load_dwordx4 v[96:99], v4, s[24:27], s57 offen offset:0 sc1
    buffer_load_dwordx4 v[100:103], v4, s[24:27], s57 offen offset:1024 sc1
    buffer_load_dwordx4 v[104:107], v4, s[24:27], s57 offen offset:2048 sc1
    buffer_load_dwordx4 v[108:111], v4, s[24:27], s57 offen offset:3072 sc1
    s_add_u32 s57, s57, 4096
    s_cmp_lg_u32 s31, 5
    s_cbranch_scc1 KH_HVDONE
    buffer_load_dwordx4 v[112:115], v4, s[24:27], s56 offen offset:0 sc1
    buffer_load_dwordx4 v[116:119], v4, s[24:27], s56 offen offset:1024 sc1
    buffer_load_dwordx4 v[120:123], v4, s[24:27], s56 offen offset:2048 sc1
    buffer_load_dwordx4 v[124:127], v4, s[24:27], s56 offen offset:3072 sc1
    s_add_u32 s56, s56, 4096
    buffer_load_dwordx4 v[128:131], v4, s[24:27], s56 offen offset:0 sc1
    buffer_load_dwordx4 v[132:135], v4, s[24:27], s56 offen offset:1024 sc1
    buffer_load_dwordx4 v[136:139], v4, s[24:27], s56 offen offset:2048 sc1
    buffer_load_dwordx4 v[140:143], v4, s[24:27], s56 offen offset:3072 sc1
    s_add_u32 s56, s56, 4096
    buffer_load_dwordx4 v[144:147], v4, s[24:27], s56 offen offset:0 sc1
    buffer_load_dwordx4 v[148:151], v4, s[24:27], s56 offen offset:1024 sc1
    buffer_load_dwordx4 v[152:155], v4, s[24:27], s56 offen offset:2048 sc1
    buffer_load_dwordx4 v[156:159], v4, s[24:27], s56 offen offset:3072 sc1
    s_add_u32 s56, s56, 4096
    buffer_load_dwordx4 v[160:163], v4, s[24:27], s56 offen offset:0 sc1
    buffer_load_dwordx4 v[164:167], v4, s[24:27], s56 offen offset:1024 sc1
    buffer_load_dwordx4 v[168:171], v4, s[24:27], s56 offen offset:2048 sc1
    buffer_load_dwordx4 v[172:175], v4, s[24:27], s56 offen offset:3072 sc1
    s_add_u32 s56, s56, 4096
    buffer_load_dwordx4 v[176:179], v4, s[24:27], s56 offen offset:0 sc1
    buffer_load_dwordx4 v[180:183], v4, s[24:27], s56 offen offset:1024 sc1
    buffer_load_dwordx4 v[184:187], v4, s[24:27], s56 offen offset:2048 sc1
    buffer_load_dwordx4 v[188:191], v4, s[24:27], s56 offen offset:3072 sc1
    s_add_u32 s56, s56, 4096
KH_HVDONE:
    s_barrier
    s_cmp_lg_u32 s31, 4
    s_cbranch_scc1 KH_NOPUB3
    buffer_store_dword v9, v8, s[24:27], s36 offen sc1
KH_NOPUB3:
    s_add_u32 s54, s53, 81920
    s_mov_b32 m0, s54
    s_nop 0
    buffer_load_dwordx4 v4, s[24:27], s52 offen offset:0 sc1 lds
    buffer_load_dwordx4 v4, s[24:27], s52 offen offset:1024 sc1 lds
    buffer_load_dwordx4 v4, s[24:27], s52 offen offset:2048 sc1 lds
    buffer_load_dwordx4 v4, s[24:27], s52 offen offset:3072 sc1 lds
    s_add_u32 s52, s52, 4096
    s_add_u32 s54, s53, 98304
    s_mov_b32 m0, s54
    s_nop 0
    buffer_load_dwordx4 v4, s[24:27], s52 offen offset:0 sc1 lds
    buffer_load_dwordx4 v4, s[24:27], s52 offen offset:1024 sc1 lds
    buffer_load_dwordx4 v4, s[24:27], s52 offen offset:2048 sc1 lds
    buffer_load_dwordx4 v4, s[24:27], s52 offen offset:3072 sc1 lds
    s_add_u32 s52, s52, 4096
    s_cmp_lg_u32 s31, 4
    s_cbranch_scc1 KH4_OTHER
    s_mov_b32 s55, 0
KH4_POLL:
    buffer_load_dword v24, v11, s[24:27], s46 offen sc1
    s_waitcnt vmcnt(0)
    v_cmp_ne_u32 s[58:59], s72, v24
    s_add_u32 s55, s55, 1
    s_nop 2
    s_cmp_eq_u64 s[58:59], 0
    s_cbranch_scc1 KH4_DONE
    s_mov_b64 exec, s[58:59]
    s_sleep 1
    s_cmp_lt_u32 s55, 0x40000
    s_cbranch_scc1 KH4_POLL
KH4_DONE:
    s_mov_b64 exec, -1
    s_barrier
    s_endpgm
KH4_OTHER:
    v_add_u32 v5, s53, v4
    v_add_u32 v6, 0x10000, v5
    v_add_u32 v7, 0x20000, v5
    v_mov_b32 v8, v4
    v_add_u32 v9, 0x10000, v4
    v_add_u32 v10, 0x20000, v4
    s_cmp_lg_u32 s31, 5
    s_cbranch_scc1 KH4_ONE
    s_waitcnt vmcnt(0)
    s_barrier
    s_barrier
    ds_write_b128 v6, v[32:35] offset:49152
    ds_write_b128 v6, v[36:39] offset:50176
    ds_write_b128 v6, v[40:43] offset:51200
    ds_write_b128 v6, v[44:47] offset:52224
    ds_write_b128 v9, v[112:115] offset:49152
    ds_write_b128 v9, v[116:119] offset:50176
    ds_write_b128 v9, v[120:123] offset:51200
    ds_write_b128 v9, v[124:127] offset:52224
    ds_write_b128 v7, v[48:51] offset:0
    ds_write_b128 v7, v[52:55] offset:1024
    ds_write_b128 v7, v[56:59] offset:2048
    ds_write_b128 v7, v[60:63] offset:3072
    ds_write_b128 v10, v[128:131] offset:0
    ds_write_b128 v10, v[132:135] offset:1024
    ds_write_b128 v10, v[136:139] offset:2048
    ds_write_b128 v10, v[140:143] offset:3072
    ds_write_b128 v5, v[64:67] offset:0
    ds_write_b128 v5, v[68:71] offset:1024
    ds_write_b128 v5, v[72:75] offset:2048
    ds_write_b128 v5, v[76:79] offset:3072
    ds_write_b128 v8, v[144:147] offset:0
    ds_write_b128 v8, v[148:151] offset:1024
    ds_write_b128 v8, v[152:155] offset:2048
    ds_write_b128 v8, v[156:159] offset:3072
    s_waitcnt lgkmcnt(0)
    s_barrier
    ds_write_b128 v5, v[80:83] offset:16384
    ds_write_b128 v5, v[84:87] offset:17408
    ds_write_b128 v5, v[88:91] offset:18432
    ds_write_b128 v5, v[92:95] offset:19456
    ds_write_b128 v8, v[160:163] offset:16384
    ds_write_b128 v8, v[164:167] offset:17408
    ds_write_b128 v8, v[168:171] offset:18432
    ds_write_b128 v8, v[172:175] offset:19456
    ds_write_b128 v5, v[96:99] offset:32768
    ds_write_b128 v5, v[100:103] offset:33792
    ds_write_b128 v5, v[104:107] offset:34816
    ds_write_b128 v5, v[108:111] offset:35840
    ds_write_b128 v8, v[176:179] offset:32768
    ds_write_b128 v8, v[180:183] offset:33792
    ds_write_b128 v8, v[184:187] offset:34816
    ds_write_b128 v8, v[188:191] offset:35840
    s_waitcnt lgkmcnt(0)
    s_barrier
    s_endpgm
KH4_ONE:
    s_waitcnt vmcnt(0)
    s_barrier
    s_barrier
    ds_write_b128 v6, v[32:35] offset:49152
    ds_write_b128 v6, v[36:39] offset:50176
    ds_write_b128 v6, v[40:43] offset:51200
    ds_write_b128 v6, v[44:47] offset:52224
    ds_write_b128 v7, v[48:51] offset:0
    ds_write_b128 v7, v[52:55] offset:1024
    ds_write_b128 v7, v[56:59] offset:2048
    ds_write_b128 v7, v[60:63] offset:3072
    ds_write_b128 v5, v[64:67] offset:0
    ds_write_b128 v5, v[68:71] offset:1024
    ds_write_b128 v5, v[72:75] offset:2048
    ds_write_b128 v5, v[76:79] offset:3072
    s_waitcnt lgkmcnt(0)
    s_barrier
    ds_write_b128 v5, v[80:83] offset:16384
    ds_write_b128 v5, v[84:87] offset:17408
    ds_write_b128 v5, v[88:91] offset:18432
    ds_write_b128 v5, v[92:95] offset:19456
    ds_write_b128 v5, v[96:99] offset:32768
    ds_write_b128 v5, v[100:103] offset:33792
    ds_write_b128 v5, v[104:107] offset:34816
    ds_write_b128 v5, v[108:111] offset:35840
    s_waitcnt lgkmcnt(0)
    s_barrier
    s_endpgm
KC_COMPUTE:
    s_and_b32 s28, s2, 31
    s_lshr_b32 s30, s2, 5
    v_lshrrev_b32 v62, 3, v1
    v_lshlrev_b32 v62, 10, v62
    v_and_b32 v5, 7, v1
    v_lshl_add_u32 v62, v5, 4, v62
    v_and_b32 v5, 3, v1
    s_lshl_b32 s36, s28, 16
    s_lshl_b32 s37, s30, 7
    s_add_u32 s36, s36, s37
    s_lshl_b32 s37, s30, 6
    s_lshl_b32 s38, s31, 14
    s_add_u32 s36, s36, s38
    s_add_u32 s39, s36, 8192
    s_lshl_b32 s38, s31, 11
    s_add_u32 s38, s38, 114688
    s_lshl_b32 s40, s31, 4
    v_add_u32 v6, s40, v2
    v_lshl_add_u32 v7, v6, 5, s28
    v_sub_u32 v8, 0x800, v7
    v_and_b32 v8, 0x7ff, v8
    v_lshlrev_b32 v7, 10, v7
    v_lshl_add_u32 v7, v3, 4, v7
    v_lshlrev_b32 v13, 10, v8
    v_lshl_add_u32 v9, v3, 4, s37
    v_sub_u32 v10, 1008, v9
    v_add_u32 v10, v13, v10
    v_sub_u32 v11, 1024, v9
    v_cmp_eq_u32 vcc, 0, v9
    v_mov_b32 v12, 512
    s_nop 0
    v_cndmask_b32 v11, v11, v12, vcc
    v_add_u32 v11, v13, v11
    v_cndmask_b32 v61, 1.0, 0, vcc
    s_and_b32 s61, s2, 7
    s_lshr_b32 s29, s2, 3
    s_lshr_b32 s60, s61, 1
    s_lshl_b32 s60, s60, 2
    s_and_b32 s3, s29, 3
    s_add_u32 s60, s60, s3
    s_and_b32 s61, s61, 1
    s_lshl_b32 s61, s61, 3
    s_lshr_b32 s29, s29, 2
    s_add_u32 s61, s61, s29
    s_mul_i32 s62, s31, 7168
    s_mul_i32 s63, s61, 114688
    s_add_u32 s63, s63, s62
    s_add_u32 s63, s63, 16777216
    buffer_load_dwordx4 v[16:19], v7, s[12:15], s37 offen
    buffer_load_dwordx4 v[20:23], v10, s[12:15], 0 offen
    buffer_load_ushort v25, v11, s[12:15], 0 offen
    s_lshl_b32 s40, s28, 2
    s_add_u32 s40, s40, s31
    s_lshl_b32 s40, s40, 4
    s_add_u32 s40, s40, s30
    s_lshl_b32 s42, s40, 10
    s_add_u32 s42, s42, 4194304
    s_lshl_b32 s43, s40, 7
    s_add_u32 s43, s43, 2228224
    v_and_b32 v9, 31, v8
    v_lshrrev_b32 v8, 5, v8
    v_lshl_add_u32 v8, v9, 6, v8
    v_lshrrev_b32 v9, 4, v8
    v_and_b32 v8, 15, v8
    v_lshlrev_b32 v10, 14, v9
    v_lshl_add_u32 v10, v3, 8, v10
    v_lshl_add_u32 v10, v8, 4, v10
    v_lshlrev_b32 v11, 11, v9
    v_lshl_add_u32 v11, v8, 3, v11
    s_add_u32 s44, s30, 8
    s_lshl_b32 s45, s44, 7
    s_add_u32 s45, s45, 2228224
    s_lshl_b32 s44, s44, 10
    s_add_u32 s44, s44, 4194304
    v_cvt_f32_u32 v13, v6
    v_mul_f32 v13, 0x3c800000, v13
    v_cvt_f32_u32 v12, v3
    v_mul_f32 v12, 4.0, v12
    v_mul_f32 v12, v12, v13
    v_mul_f32 v63, 0x41500000, v13
    v_cos_f32 v15, v12
    v_sin_f32 v14, v12
    v_add_f32 v12, v12, v13
    v_cvt_pk_bf16_f32 v32, v15, v14
    v_cos_f32 v15, v12
    v_sin_f32 v14, v12
    v_add_f32 v12, v12, v13
    v_cvt_pk_bf16_f32 v33, v15, v14
    v_cos_f32 v15, v12
    v_sin_f32 v14, v12
    v_add_f32 v12, v12, v13
    v_cvt_pk_bf16_f32 v34, v15, v14
    v_cos_f32 v15, v12
    v_sin_f32 v14, v12
    v_add_f32 v12, v12, v63
    v_cvt_pk_bf16_f32 v35, v15, v14
    v_cos_f32 v15, v12
    v_sin_f32 v14, v12
    v_add_f32 v12, v12, v13
    v_cvt_pk_bf16_f32 v36, v15, v14
    v_cos_f32 v15, v12
    v_sin_f32 v14, v12
    v_add_f32 v12, v12, v13
    v_cvt_pk_bf16_f32 v37, v15, v14
    v_cos_f32 v15, v12
    v_sin_f32 v14, v12
    v_add_f32 v12, v12, v13
    v_cvt_pk_bf16_f32 v38, v15, v14
    v_cos_f32 v15, v12
    v_sin_f32 v14, v12
    v_add_f32 v12, v12, v63
    v_cvt_pk_bf16_f32 v39, v15, v14
    v_cos_f32 v15, v12
    v_sin_f32 v14, v12
    v_add_f32 v12, v12, v13
    v_cvt_pk_bf16_f32 v40, v15, v14
    v_cos_f32 v15, v12
    v_sin_f32 v14, v12
    v_add_f32 v12, v12, v13
    v_cvt_pk_bf16_f32 v41, v15, v14
    v_cos_f32 v15, v12
    v_sin_f32 v14, v12
    v_add_f32 v12, v12, v13
    v_cvt_pk_bf16_f32 v42, v15, v14
    v_cos_f32 v15, v12
    v_sin_f32 v14, v12
    v_add_f32 v12, v12, v63
    v_cvt_pk_bf16_f32 v43, v15, v14
    v_cos_f32 v15, v12
    v_sin_f32 v14, v12
    v_add_f32 v12, v12, v13
    v_cvt_pk_bf16_f32 v44, v15, v14
    v_cos_f32 v15, v12
    v_sin_f32 v14, v12
    v_add_f32 v12, v12, v13
    v_cvt_pk_bf16_f32 v45, v15, v14
    v_cos_f32 v15, v12
    v_sin_f32 v14, v12
    v_add_f32 v12, v12, v13
    v_cvt_pk_bf16_f32 v46, v15, v14
    v_cos_f32 v15, v12
    v_sin_f32 v14, v12
    v_add_f32 v12, v12, v63
    v_cvt_pk_bf16_f32 v47, v15, v14
    v_lshrrev_b32 v12, 3, v2
    v_lshl_add_u32 v12, v3, 2, v12
    v_lshlrev_b32 v12, 7, v12
    v_lshl_add_u32 v12, v5, 5, v12
    v_bfe_u32 v13, v2, 2, 1
    v_lshl_add_u32 v12, v13, 3, v12
    v_add_u32 v12, 114688, v12
    s_mov_b32 s41, 0xffff0000
    s_barrier
    s_mov_b32 m0, s38
    s_nop 0
    buffer_load_dwordx4 v62, s[24:27], s36 offen sc1 lds
    s_add_u32 s38, s38, 1024
    s_mov_b32 m0, s38
    s_nop 0
    buffer_load_dwordx4 v62, s[24:27], s39 offen sc1 lds
    s_waitcnt vmcnt(0)
    s_barrier
    ds_read_b64_tr_b16 v[64:65], v12 offset:0
    ds_read_b64_tr_b16 v[66:67], v12 offset:256
    ds_read_b64_tr_b16 v[68:69], v12 offset:16
    ds_read_b64_tr_b16 v[70:71], v12 offset:272
    ds_read_b64_tr_b16 v[72:73], v12 offset:2048
    ds_read_b64_tr_b16 v[74:75], v12 offset:2304
    ds_read_b64_tr_b16 v[76:77], v12 offset:2064
    ds_read_b64_tr_b16 v[78:79], v12 offset:2320
    ds_read_b64_tr_b16 v[80:81], v12 offset:4096
    ds_read_b64_tr_b16 v[82:83], v12 offset:4352
    ds_read_b64_tr_b16 v[84:85], v12 offset:4112
    ds_read_b64_tr_b16 v[86:87], v12 offset:4368
    ds_read_b64_tr_b16 v[88:89], v12 offset:6144
    ds_read_b64_tr_b16 v[90:91], v12 offset:6400
    ds_read_b64_tr_b16 v[92:93], v12 offset:6160
    ds_read_b64_tr_b16 v[94:95], v12 offset:6416
    s_waitcnt lgkmcnt(12)
    v_mfma_f32_16x16x32_bf16 v[48:51], v[64:67], v[32:35], 0
    v_mfma_f32_16x16x32_bf16 v[52:55], v[68:71], v[32:35], 0
    s_waitcnt lgkmcnt(8)
    v_mfma_f32_16x16x32_bf16 v[48:51], v[72:75], v[36:39], v[48:51]
    v_mfma_f32_16x16x32_bf16 v[52:55], v[76:79], v[36:39], v[52:55]
    s_waitcnt lgkmcnt(4)
    v_mfma_f32_16x16x32_bf16 v[48:51], v[80:83], v[40:43], v[48:51]
    v_mfma_f32_16x16x32_bf16 v[52:55], v[84:87], v[40:43], v[52:55]
    s_waitcnt lgkmcnt(0)
    v_mfma_f32_16x16x32_bf16 v[48:51], v[88:91], v[44:47], v[48:51]
    v_mfma_f32_16x16x32_bf16 v[52:55], v[92:95], v[44:47], v[52:55]
    s_waitcnt vmcnt(2)
    v_lshlrev_b32 v64, 16, v16
    v_and_b32 v65, s41, v16
    v_lshlrev_b32 v66, 16, v17
    v_and_b32 v67, s41, v17
    v_lshlrev_b32 v68, 16, v18
    v_and_b32 v69, s41, v18
    v_lshlrev_b32 v70, 16, v19
    v_and_b32 v71, s41, v19
    v_lshlrev_b32 v72, 16, v25
    v_and_b32 v73, s41, v23
    v_lshlrev_b32 v74, 16, v23
    v_and_b32 v75, s41, v22
    v_lshlrev_b32 v76, 16, v22
    v_and_b32 v77, s41, v21
    v_lshlrev_b32 v78, 16, v21
    v_and_b32 v79, s41, v20
    v_pk_add_f32 v[72:73], v[72:73], v[48:49]
    v_pk_add_f32 v[74:75], v[74:75], v[50:51]
    v_pk_add_f32 v[76:77], v[76:77], v[52:53]
    v_pk_add_f32 v[78:79], v[78:79], v[54:55]
    v_mul_f32 v48, v61, v48
    v_pk_add_f32 v[64:65], v[64:65], v[48:49]
    v_pk_add_f32 v[66:67], v[66:67], v[50:51]
    v_pk_add_f32 v[68:69], v[68:69], v[52:53]
    v_pk_add_f32 v[70:71], v[70:71], v[54:55]
    v_cvt_pk_bf16_f32 v88, v64, v65
    v_cvt_pk_bf16_f32 v89, v66, v67
    v_cvt_pk_bf16_f32 v90, v68, v69
    v_cvt_pk_bf16_f32 v91, v70, v71
    buffer_store_dwordx4 v[88:91], v4, s[24:27], s42 offen sc1
    v_cvt_pk_bf16_f32 v92, v72, v73
    v_cvt_pk_bf16_f32 v93, v74, v75
    v_cvt_pk_bf16_f32 v94, v76, v77
    v_cvt_pk_bf16_f32 v95, v78, v79
    buffer_store_dwordx4 v[92:95], v10, s[24:27], s44 offen sc1
    v_mov_b32 v13, 0x3f803f80
    v_dot2_f32_bf16 v80, v88, v13, 0
    v_dot2_f32_bf16 v81, v88, v88, 0
    v_dot2_f32_bf16 v82, v92, v13, 0
    v_dot2_f32_bf16 v83, v92, v92, 0
    v_dot2_f32_bf16 v80, v89, v13, v80
    v_dot2_f32_bf16 v81, v89, v89, v81
    v_dot2_f32_bf16 v82, v93, v13, v82
    v_dot2_f32_bf16 v83, v93, v93, v83
    v_dot2_f32_bf16 v80, v90, v13, v80
    v_dot2_f32_bf16 v81, v90, v90, v81
    v_dot2_f32_bf16 v82, v94, v13, v82
    v_dot2_f32_bf16 v83, v94, v94, v83
    v_dot2_f32_bf16 v80, v91, v13, v80
    v_dot2_f32_bf16 v81, v91, v91, v81
    v_dot2_f32_bf16 v82, v95, v13, v82
    v_dot2_f32_bf16 v83, v95, v95, v83
    v_mov_b32 v84, v80
    v_mov_b32 v85, v81
    v_mov_b32 v86, v82
    v_mov_b32 v87, v83
    v_permlane32_swap_b32 v80, v84
    v_permlane32_swap_b32 v81, v85
    v_permlane32_swap_b32 v82, v86
    v_permlane32_swap_b32 v83, v87
    v_add_f32 v80, v80, v84
    v_add_f32 v81, v81, v85
    v_add_f32 v82, v82, v86
    v_add_f32 v83, v83, v87
    v_mov_b32 v84, v80
    v_mov_b32 v85, v81
    v_mov_b32 v86, v82
    v_mov_b32 v87, v83
    v_permlane16_swap_b32 v80, v84
    v_permlane16_swap_b32 v81, v85
    v_permlane16_swap_b32 v82, v86
    v_permlane16_swap_b32 v83, v87
    v_add_f32 v80, v80, v84
    v_add_f32 v81, v81, v85
    v_add_f32 v82, v82, v86
    v_add_f32 v83, v83, v87
    v_lshlrev_b32 v7, 3, v1
    s_mov_b64 exec, 0xffff
    buffer_store_dwordx2 v[80:81], v7, s[24:27], s43 offen sc1
    buffer_store_dwordx2 v[82:83], v11, s[24:27], s45 offen sc1
    s_mov_b64 exec, -1
    s_lshl_b32 s36, s28, 3
    s_add_u32 s36, s36, s30
    s_lshl_b32 s36, s36, 7
    s_add_u32 s36, s36, 3670016
    s_waitcnt vmcnt(0)
    s_barrier
    s_mov_b32 s30, s60
    s_mov_b32 s28, s61
    s_lshl_b32 s32, s30, 3
    s_lshl_b32 s33, s31, 1
    s_add_u32 s32, s32, s33
    s_lshl_b32 s33, s32, 14
    s_add_u32 s33, s33, 4194304
    s_add_u32 s34, s33, 16384
    v_add_u32 v5, 57344, v4
    s_and_b32 s36, s31, 1
    s_lshl_b32 s36, s36, 6
    v_add_u32 v60, s36, v1
    v_min_u32 v60, 0x6f, v60
    v_lshlrev_b32 v60, 2, v60
    s_mul_i32 s36, s28, 448
    s_add_u32 s36, s36, 3145728
    buffer_load_dword v32, v60, s[24:27], s36 offen sc1
    s_add_u32 s36, s36, 7168
    buffer_load_dword v33, v60, s[24:27], s36 offen sc1
    s_add_u32 s36, s36, 7168
    buffer_load_dword v34, v60, s[24:27], s36 offen sc1
    s_add_u32 s36, s36, 7168
    buffer_load_dword v35, v60, s[24:27], s36 offen sc1
    s_add_u32 s36, s36, 7168
    buffer_load_dword v36, v60, s[24:27], s36 offen sc1
    s_add_u32 s36, s36, 7168
    buffer_load_dword v37, v60, s[24:27], s36 offen sc1
    s_add_u32 s36, s36, 7168
    buffer_load_dword v38, v60, s[24:27], s36 offen sc1
    s_add_u32 s36, s36, 7168
    buffer_load_dword v39, v60, s[24:27], s36 offen sc1
    s_add_u32 s36, s36, 7168
    buffer_load_dword v40, v60, s[24:27], s36 offen sc1
    s_add_u32 s36, s36, 7168
    buffer_load_dword v41, v60, s[24:27], s36 offen sc1
    s_add_u32 s36, s36, 7168
    buffer_load_dword v42, v60, s[24:27], s36 offen sc1
    s_add_u32 s36, s36, 7168
    buffer_load_dword v43, v60, s[24:27], s36 offen sc1
    s_add_u32 s36, s36, 7168
    buffer_load_dword v44, v60, s[24:27], s36 offen sc1
    s_add_u32 s36, s36, 7168
    buffer_load_dword v45, v60, s[24:27], s36 offen sc1
    s_add_u32 s36, s36, 7168
    buffer_load_dword v46, v60, s[24:27], s36 offen sc1
    s_add_u32 s36, s36, 7168
    buffer_load_dword v47, v60, s[24:27], s36 offen sc1
    s_and_b32 s48, s2, 7
    s_lshr_b32 s49, s2, 3
    s_lshl_b32 s50, s48, 2
    s_and_b32 s3, s49, 3
    s_add_u32 s50, s50, s3
    s_lshr_b32 s48, s49, 2
    s_mul_i32 s52, s48, 229376
    s_mul_i32 s53, s31, 57344
    s_add_u32 s52, s52, s53
    s_add_u32 s52, s52, 18874368
    s_lshl_b32 s53, s31, 12
    s_waitcnt vmcnt(0)
    v_pk_add_f32 v[32:33], v[32:33], v[40:41]
    v_pk_add_f32 v[34:35], v[34:35], v[42:43]
    v_pk_add_f32 v[36:37], v[36:37], v[44:45]
    v_pk_add_f32 v[38:39], v[38:39], v[46:47]
    v_pk_add_f32 v[32:33], v[32:33], v[36:37]
    v_pk_add_f32 v[34:35], v[34:35], v[38:39]
    v_pk_add_f32 v[32:33], v[32:33], v[34:35]
    v_add_f32 v32, v32, v33
    v_add_u32 v60, 147456, v60
    ds_write_b32 v60, v32
    s_waitcnt lgkmcnt(0)
    s_barrier
    buffer_load_dwordx4 v[176:179], v4, s[24:27], s33 offen offset:0 sc1
    buffer_load_dwordx4 v[180:183], v4, s[24:27], s34 offen offset:0 sc1
    buffer_load_dwordx4 v[184:187], v4, s[24:27], s33 offen offset:1024 sc1
    buffer_load_dwordx4 v[188:191], v4, s[24:27], s34 offen offset:1024 sc1
    buffer_load_dwordx4 v[192:195], v4, s[24:27], s33 offen offset:2048 sc1
    buffer_load_dwordx4 v[196:199], v4, s[24:27], s34 offen offset:2048 sc1
    buffer_load_dwordx4 v[200:203], v4, s[24:27], s33 offen offset:3072 sc1
    s_add_u32 s33, s33, 4096
    buffer_load_dwordx4 v[204:207], v4, s[24:27], s34 offen offset:3072 sc1
    s_add_u32 s34, s34, 4096
    buffer_load_dwordx4 v[208:211], v4, s[24:27], s33 offen offset:0 sc1
    buffer_load_dwordx4 v[212:215], v4, s[24:27], s34 offen offset:0 sc1
    ds_read_b128 v[64:67], v4 offset:0
    ds_read_b128 v[68:71], v4 offset:1024
    ds_read_b128 v[72:75], v4 offset:2048
    ds_read_b128 v[76:79], v4 offset:3072
    ds_read_b128 v[80:83], v4 offset:4096
    ds_read_b128 v[84:87], v4 offset:5120
    ds_read_b128 v[88:91], v4 offset:6144
    s_waitcnt vmcnt(8) lgkmcnt(0)
    v_mfma_f32_16x16x32_bf16 v[120:123], v[64:67], v[176:179], 0
    ds_read_b128 v[92:95], v4 offset:7168
    v_mfma_f32_16x16x32_bf16 v[148:151], v[64:67], v[180:183], 0
    ds_read_b128 v[96:99], v4 offset:8192
    v_mfma_f32_16x16x32_bf16 v[124:127], v[68:71], v[176:179], 0
    ds_read_b128 v[100:103], v4 offset:9216
    v_mfma_f32_16x16x32_bf16 v[152:155], v[68:71], v[180:183], 0
    ds_read_b128 v[104:107], v4 offset:10240
    v_mfma_f32_16x16x32_bf16 v[128:131], v[72:75], v[176:179], 0
    ds_read_b128 v[108:111], v4 offset:11264
    v_mfma_f32_16x16x32_bf16 v[156:159], v[72:75], v[180:183], 0
    ds_read_b128 v[112:115], v4 offset:12288
    v_mfma_f32_16x16x32_bf16 v[132:135], v[76:79], v[176:179], 0
    ds_read_b128 v[116:119], v4 offset:13312
    v_mfma_f32_16x16x32_bf16 v[160:163], v[76:79], v[180:183], 0
    buffer_load_dwordx4 v[216:219], v4, s[24:27], s33 offen offset:1024 sc1
    v_mfma_f32_16x16x32_bf16 v[136:139], v[80:83], v[176:179], 0
    buffer_load_dwordx4 v[220:223], v4, s[24:27], s34 offen offset:1024 sc1
    v_mfma_f32_16x16x32_bf16 v[164:167], v[80:83], v[180:183], 0
    v_mfma_f32_16x16x32_bf16 v[140:143], v[84:87], v[176:179], 0
    v_mfma_f32_16x16x32_bf16 v[168:171], v[84:87], v[180:183], 0
    v_mfma_f32_16x16x32_bf16 v[144:147], v[88:91], v[176:179], 0
    v_mfma_f32_16x16x32_bf16 v[172:175], v[88:91], v[180:183], 0
    s_waitcnt vmcnt(8) lgkmcnt(0)
    v_mfma_f32_16x16x32_bf16 v[120:123], v[92:95], v[184:187], v[120:123]
    ds_read_b128 v[64:67], v4 offset:14336
    v_mfma_f32_16x16x32_bf16 v[148:151], v[92:95], v[188:191], v[148:151]
    ds_read_b128 v[68:71], v4 offset:15360
    v_mfma_f32_16x16x32_bf16 v[124:127], v[96:99], v[184:187], v[124:127]
    ds_read_b128 v[72:75], v4 offset:16384
    v_mfma_f32_16x16x32_bf16 v[152:155], v[96:99], v[188:191], v[152:155]
    ds_read_b128 v[76:79], v4 offset:17408
    v_mfma_f32_16x16x32_bf16 v[128:131], v[100:103], v[184:187], v[128:131]
    ds_read_b128 v[80:83], v4 offset:18432
    v_mfma_f32_16x16x32_bf16 v[156:159], v[100:103], v[188:191], v[156:159]
    ds_read_b128 v[84:87], v4 offset:19456
    v_mfma_f32_16x16x32_bf16 v[132:135], v[104:107], v[184:187], v[132:135]
    ds_read_b128 v[88:91], v4 offset:20480
    v_mfma_f32_16x16x32_bf16 v[160:163], v[104:107], v[188:191], v[160:163]
    buffer_load_dwordx4 v[176:179], v4, s[24:27], s33 offen offset:2048 sc1
    v_mfma_f32_16x16x32_bf16 v[136:139], v[108:111], v[184:187], v[136:139]
    buffer_load_dwordx4 v[180:183], v4, s[24:27], s34 offen offset:2048 sc1
    v_mfma_f32_16x16x32_bf16 v[164:167], v[108:111], v[188:191], v[164:167]
    v_mfma_f32_16x16x32_bf16 v[140:143], v[112:115], v[184:187], v[140:143]
    v_mfma_f32_16x16x32_bf16 v[168:171], v[112:115], v[188:191], v[168:171]
    v_mfma_f32_16x16x32_bf16 v[144:147], v[116:119], v[184:187], v[144:147]
    v_mfma_f32_16x16x32_bf16 v[172:175], v[116:119], v[188:191], v[172:175]
    s_waitcnt vmcnt(8) lgkmcnt(0)
    v_mfma_f32_16x16x32_bf16 v[120:123], v[64:67], v[192:195], v[120:123]
    ds_read_b128 v[92:95], v4 offset:21504
    v_mfma_f32_16x16x32_bf16 v[148:151], v[64:67], v[196:199], v[148:151]
    ds_read_b128 v[96:99], v4 offset:22528
    v_mfma_f32_16x16x32_bf16 v[124:127], v[68:71], v[192:195], v[124:127]
    ds_read_b128 v[100:103], v4 offset:23552
    v_mfma_f32_16x16x32_bf16 v[152:155], v[68:71], v[196:199], v[152:155]
    ds_read_b128 v[104:107], v4 offset:24576
    v_mfma_f32_16x16x32_bf16 v[128:131], v[72:75], v[192:195], v[128:131]
    ds_read_b128 v[108:111], v4 offset:25600
    v_mfma_f32_16x16x32_bf16 v[156:159], v[72:75], v[196:199], v[156:159]
    ds_read_b128 v[112:115], v4 offset:26624
    v_mfma_f32_16x16x32_bf16 v[132:135], v[76:79], v[192:195], v[132:135]
    ds_read_b128 v[116:119], v4 offset:27648
    v_mfma_f32_16x16x32_bf16 v[160:163], v[76:79], v[196:199], v[160:163]
    buffer_load_dwordx4 v[184:187], v4, s[24:27], s33 offen offset:3072 sc1
    s_add_u32 s33, s33, 4096
    v_mfma_f32_16x16x32_bf16 v[136:139], v[80:83], v[192:195], v[136:139]
    buffer_load_dwordx4 v[188:191], v4, s[24:27], s34 offen offset:3072 sc1
    s_add_u32 s34, s34, 4096
    v_mfma_f32_16x16x32_bf16 v[164:167], v[80:83], v[196:199], v[164:167]
    v_mfma_f32_16x16x32_bf16 v[140:143], v[84:87], v[192:195], v[140:143]
    v_mfma_f32_16x16x32_bf16 v[168:171], v[84:87], v[196:199], v[168:171]
    v_mfma_f32_16x16x32_bf16 v[144:147], v[88:91], v[192:195], v[144:147]
    v_mfma_f32_16x16x32_bf16 v[172:175], v[88:91], v[196:199], v[172:175]
    s_waitcnt vmcnt(8) lgkmcnt(0)
    v_mfma_f32_16x16x32_bf16 v[120:123], v[92:95], v[200:203], v[120:123]
    ds_read_b128 v[64:67], v4 offset:28672
    v_mfma_f32_16x16x32_bf16 v[148:151], v[92:95], v[204:207], v[148:151]
    ds_read_b128 v[68:71], v4 offset:29696
    v_mfma_f32_16x16x32_bf16 v[124:127], v[96:99], v[200:203], v[124:127]
    ds_read_b128 v[72:75], v4 offset:30720
    v_mfma_f32_16x16x32_bf16 v[152:155], v[96:99], v[204:207], v[152:155]
    ds_read_b128 v[76:79], v4 offset:31744
    v_mfma_f32_16x16x32_bf16 v[128:131], v[100:103], v[200:203], v[128:131]
    ds_read_b128 v[80:83], v4 offset:32768
    v_mfma_f32_16x16x32_bf16 v[156:159], v[100:103], v[204:207], v[156:159]
    ds_read_b128 v[84:87], v4 offset:33792
    v_mfma_f32_16x16x32_bf16 v[132:135], v[104:107], v[200:203], v[132:135]
    ds_read_b128 v[88:91], v4 offset:34816
    v_mfma_f32_16x16x32_bf16 v[160:163], v[104:107], v[204:207], v[160:163]
    buffer_load_dwordx4 v[192:195], v4, s[24:27], s33 offen offset:0 sc1
    v_mfma_f32_16x16x32_bf16 v[136:139], v[108:111], v[200:203], v[136:139]
    buffer_load_dwordx4 v[196:199], v4, s[24:27], s34 offen offset:0 sc1
    v_mfma_f32_16x16x32_bf16 v[164:167], v[108:111], v[204:207], v[164:167]
    v_mfma_f32_16x16x32_bf16 v[140:143], v[112:115], v[200:203], v[140:143]
    v_mfma_f32_16x16x32_bf16 v[168:171], v[112:115], v[204:207], v[168:171]
    v_mfma_f32_16x16x32_bf16 v[144:147], v[116:119], v[200:203], v[144:147]
    v_mfma_f32_16x16x32_bf16 v[172:175], v[116:119], v[204:207], v[172:175]
    s_waitcnt vmcnt(8) lgkmcnt(0)
    v_mfma_f32_16x16x32_bf16 v[120:123], v[64:67], v[208:211], v[120:123]
    ds_read_b128 v[92:95], v4 offset:35840
    v_mfma_f32_16x16x32_bf16 v[148:151], v[64:67], v[212:215], v[148:151]
    ds_read_b128 v[96:99], v4 offset:36864
    v_mfma_f32_16x16x32_bf16 v[124:127], v[68:71], v[208:211], v[124:127]
    ds_read_b128 v[100:103], v4 offset:37888
    v_mfma_f32_16x16x32_bf16 v[152:155], v[68:71], v[212:215], v[152:155]
    ds_read_b128 v[104:107], v4 offset:38912
    v_mfma_f32_16x16x32_bf16 v[128:131], v[72:75], v[208:211], v[128:131]
    ds_read_b128 v[108:111], v4 offset:39936
    v_mfma_f32_16x16x32_bf16 v[156:159], v[72:75], v[212:215], v[156:159]
    ds_read_b128 v[112:115], v4 offset:40960
    v_mfma_f32_16x16x32_bf16 v[132:135], v[76:79], v[208:211], v[132:135]
    ds_read_b128 v[116:119], v4 offset:41984
    v_mfma_f32_16x16x32_bf16 v[160:163], v[76:79], v[212:215], v[160:163]
    buffer_load_dwordx4 v[200:203], v4, s[24:27], s33 offen offset:1024 sc1
    v_mfma_f32_16x16x32_bf16 v[136:139], v[80:83], v[208:211], v[136:139]
    buffer_load_dwordx4 v[204:207], v4, s[24:27], s34 offen offset:1024 sc1
    v_mfma_f32_16x16x32_bf16 v[164:167], v[80:83], v[212:215], v[164:167]
    v_mfma_f32_16x16x32_bf16 v[140:143], v[84:87], v[208:211], v[140:143]
    v_mfma_f32_16x16x32_bf16 v[168:171], v[84:87], v[212:215], v[168:171]
    v_mfma_f32_16x16x32_bf16 v[144:147], v[88:91], v[208:211], v[144:147]
    v_mfma_f32_16x16x32_bf16 v[172:175], v[88:91], v[212:215], v[172:175]
    s_waitcnt vmcnt(8) lgkmcnt(0)
    v_mfma_f32_16x16x32_bf16 v[120:123], v[92:95], v[216:219], v[120:123]
    ds_read_b128 v[64:67], v4 offset:43008
    v_mfma_f32_16x16x32_bf16 v[148:151], v[92:95], v[220:223], v[148:151]
    ds_read_b128 v[68:71], v4 offset:44032
    v_mfma_f32_16x16x32_bf16 v[124:127], v[96:99], v[216:219], v[124:127]
    ds_read_b128 v[72:75], v4 offset:45056
    v_mfma_f32_16x16x32_bf16 v[152:155], v[96:99], v[220:223], v[152:155]
    ds_read_b128 v[76:79], v4 offset:46080
    v_mfma_f32_16x16x32_bf16 v[128:131], v[100:103], v[216:219], v[128:131]
    ds_read_b128 v[80:83], v4 offset:47104
    v_mfma_f32_16x16x32_bf16 v[156:159], v[100:103], v[220:223], v[156:159]
    ds_read_b128 v[84:87], v4 offset:48128
    v_mfma_f32_16x16x32_bf16 v[132:135], v[104:107], v[216:219], v[132:135]
    ds_read_b128 v[88:91], v4 offset:49152
    v_mfma_f32_16x16x32_bf16 v[160:163], v[104:107], v[220:223], v[160:163]
    buffer_load_dwordx4 v[208:211], v4, s[24:27], s33 offen offset:2048 sc1
    v_mfma_f32_16x16x32_bf16 v[136:139], v[108:111], v[216:219], v[136:139]
    buffer_load_dwordx4 v[212:215], v4, s[24:27], s34 offen offset:2048 sc1
    v_mfma_f32_16x16x32_bf16 v[164:167], v[108:111], v[220:223], v[164:167]
    v_mfma_f32_16x16x32_bf16 v[140:143], v[112:115], v[216:219], v[140:143]
    v_mfma_f32_16x16x32_bf16 v[168:171], v[112:115], v[220:223], v[168:171]
    v_mfma_f32_16x16x32_bf16 v[144:147], v[116:119], v[216:219], v[144:147]
    v_mfma_f32_16x16x32_bf16 v[172:175], v[116:119], v[220:223], v[172:175]
    s_waitcnt vmcnt(8) lgkmcnt(0)
    v_mfma_f32_16x16x32_bf16 v[120:123], v[64:67], v[176:179], v[120:123]
    ds_read_b128 v[92:95], v4 offset:50176
    v_mfma_f32_16x16x32_bf16 v[148:151], v[64:67], v[180:183], v[148:151]
    ds_read_b128 v[96:99], v4 offset:51200
    v_mfma_f32_16x16x32_bf16 v[124:127], v[68:71], v[176:179], v[124:127]
    ds_read_b128 v[100:103], v4 offset:52224
    v_mfma_f32_16x16x32_bf16 v[152:155], v[68:71], v[180:183], v[152:155]
    ds_read_b128 v[104:107], v4 offset:53248
    v_mfma_f32_16x16x32_bf16 v[128:131], v[72:75], v[176:179], v[128:131]
    ds_read_b128 v[108:111], v4 offset:54272
    v_mfma_f32_16x16x32_bf16 v[156:159], v[72:75], v[180:183], v[156:159]
    ds_read_b128 v[112:115], v4 offset:55296
    v_mfma_f32_16x16x32_bf16 v[132:135], v[76:79], v[176:179], v[132:135]
    ds_read_b128 v[116:119], v4 offset:56320
    v_mfma_f32_16x16x32_bf16 v[160:163], v[76:79], v[180:183], v[160:163]
    buffer_load_dwordx4 v[216:219], v4, s[24:27], s33 offen offset:3072 sc1
    s_add_u32 s33, s33, 4096
    v_mfma_f32_16x16x32_bf16 v[136:139], v[80:83], v[176:179], v[136:139]
    buffer_load_dwordx4 v[220:223], v4, s[24:27], s34 offen offset:3072 sc1
    s_add_u32 s34, s34, 4096
    v_mfma_f32_16x16x32_bf16 v[164:167], v[80:83], v[180:183], v[164:167]
    v_lshlrev_b32 v61, 9, v3
    v_lshl_add_u32 v61, v2, 3, v61
    s_lshl_b32 s36, s32, 11
    s_add_u32 s36, s36, 2228224
    buffer_load_dwordx2 v[224:225], v61, s[24:27], s36 offen offset:0 sc1
    buffer_load_dwordx2 v[226:227], v61, s[24:27], s36 offen offset:128 sc1
    buffer_load_dwordx2 v[228:229], v61, s[24:27], s36 offen offset:256 sc1
    buffer_load_dwordx2 v[230:231], v61, s[24:27], s36 offen offset:384 sc1
    buffer_load_dwordx2 v[232:233], v61, s[24:27], s36 offen offset:2048 sc1
    buffer_load_dwordx2 v[234:235], v61, s[24:27], s36 offen offset:2176 sc1
    buffer_load_dwordx2 v[236:237], v61, s[24:27], s36 offen offset:2304 sc1
    buffer_load_dwordx2 v[238:239], v61, s[24:27], s36 offen offset:2432 sc1
    v_mfma_f32_16x16x32_bf16 v[140:143], v[84:87], v[176:179], v[140:143]
    v_mfma_f32_16x16x32_bf16 v[168:171], v[84:87], v[180:183], v[168:171]
    v_mfma_f32_16x16x32_bf16 v[144:147], v[88:91], v[176:179], v[144:147]
    v_mfma_f32_16x16x32_bf16 v[172:175], v[88:91], v[180:183], v[172:175]
    s_waitcnt vmcnt(16) lgkmcnt(0)
    v_mfma_f32_16x16x32_bf16 v[120:123], v[92:95], v[184:187], v[120:123]
    ds_read_b128 v[64:67], v5 offset:0
    v_mfma_f32_16x16x32_bf16 v[148:151], v[92:95], v[188:191], v[148:151]
    ds_read_b128 v[68:71], v5 offset:1024
    v_mfma_f32_16x16x32_bf16 v[124:127], v[96:99], v[184:187], v[124:127]
    ds_read_b128 v[72:75], v5 offset:2048
    v_mfma_f32_16x16x32_bf16 v[152:155], v[96:99], v[188:191], v[152:155]
    ds_read_b128 v[76:79], v5 offset:3072
    v_mfma_f32_16x16x32_bf16 v[128:131], v[100:103], v[184:187], v[128:131]
    ds_read_b128 v[80:83], v5 offset:4096
    v_mfma_f32_16x16x32_bf16 v[156:159], v[100:103], v[188:191], v[156:159]
    ds_read_b128 v[84:87], v5 offset:5120
    v_mfma_f32_16x16x32_bf16 v[132:135], v[104:107], v[184:187], v[132:135]
    ds_read_b128 v[88:91], v5 offset:6144
    v_mfma_f32_16x16x32_bf16 v[160:163], v[104:107], v[188:191], v[160:163]
    buffer_load_dwordx4 v[176:179], v4, s[24:27], s33 offen offset:0 sc1
    v_mfma_f32_16x16x32_bf16 v[136:139], v[108:111], v[184:187], v[136:139]
    buffer_load_dwordx4 v[180:183], v4, s[24:27], s34 offen offset:0 sc1
    v_mfma_f32_16x16x32_bf16 v[164:167], v[108:111], v[188:191], v[164:167]
    v_mfma_f32_16x16x32_bf16 v[140:143], v[112:115], v[184:187], v[140:143]
    v_mfma_f32_16x16x32_bf16 v[168:171], v[112:115], v[188:191], v[168:171]
    v_mfma_f32_16x16x32_bf16 v[144:147], v[116:119], v[184:187], v[144:147]
    v_mfma_f32_16x16x32_bf16 v[172:175], v[116:119], v[188:191], v[172:175]
    s_waitcnt vmcnt(16) lgkmcnt(0)
    s_barrier
    v_mfma_f32_16x16x32_bf16 v[120:123], v[64:67], v[192:195], v[120:123]
    ds_read_b128 v[92:95], v5 offset:7168
    v_mfma_f32_16x16x32_bf16 v[148:151], v[64:67], v[196:199], v[148:151]
    ds_read_b128 v[96:99], v5 offset:8192
    v_mfma_f32_16x16x32_bf16 v[124:127], v[68:71], v[192:195], v[124:127]
    ds_read_b128 v[100:103], v5 offset:9216
    v_mfma_f32_16x16x32_bf16 v[152:155], v[68:71], v[196:199], v[152:155]
    ds_read_b128 v[104:107], v5 offset:10240
    v_mfma_f32_16x16x32_bf16 v[128:131], v[72:75], v[192:195], v[128:131]
    ds_read_b128 v[108:111], v5 offset:11264
    v_mfma_f32_16x16x32_bf16 v[156:159], v[72:75], v[196:199], v[156:159]
    ds_read_b128 v[112:115], v5 offset:12288
    v_mfma_f32_16x16x32_bf16 v[132:135], v[76:79], v[192:195], v[132:135]
    ds_read_b128 v[116:119], v5 offset:13312
    v_mfma_f32_16x16x32_bf16 v[160:163], v[76:79], v[196:199], v[160:163]
    buffer_load_dwordx4 v[184:187], v4, s[24:27], s33 offen offset:1024 sc1
    v_mfma_f32_16x16x32_bf16 v[136:139], v[80:83], v[192:195], v[136:139]
    buffer_load_dwordx4 v[188:191], v4, s[24:27], s34 offen offset:1024 sc1
    v_mfma_f32_16x16x32_bf16 v[164:167], v[80:83], v[196:199], v[164:167]
    v_mfma_f32_16x16x32_bf16 v[140:143], v[84:87], v[192:195], v[140:143]
    v_mfma_f32_16x16x32_bf16 v[168:171], v[84:87], v[196:199], v[168:171]
    v_mfma_f32_16x16x32_bf16 v[144:147], v[88:91], v[192:195], v[144:147]
    v_mfma_f32_16x16x32_bf16 v[172:175], v[88:91], v[196:199], v[172:175]
    s_waitcnt vmcnt(16) lgkmcnt(0)
    v_mfma_f32_16x16x32_bf16 v[120:123], v[92:95], v[200:203], v[120:123]
    ds_read_b128 v[64:67], v5 offset:14336
    v_mfma_f32_16x16x32_bf16 v[148:151], v[92:95], v[204:207], v[148:151]
    ds_read_b128 v[68:71], v5 offset:15360
    v_mfma_f32_16x16x32_bf16 v[124:127], v[96:99], v[200:203], v[124:127]
    ds_read_b128 v[72:75], v5 offset:16384
    v_mfma_f32_16x16x32_bf16 v[152:155], v[96:99], v[204:207], v[152:155]
    ds_read_b128 v[76:79], v5 offset:17408
    v_mfma_f32_16x16x32_bf16 v[128:131], v[100:103], v[200:203], v[128:131]
    ds_read_b128 v[80:83], v5 offset:18432
    v_mfma_f32_16x16x32_bf16 v[156:159], v[100:103], v[204:207], v[156:159]
    ds_read_b128 v[84:87], v5 offset:19456
    v_mfma_f32_16x16x32_bf16 v[132:135], v[104:107], v[200:203], v[132:135]
    ds_read_b128 v[88:91], v5 offset:20480
    v_mfma_f32_16x16x32_bf16 v[160:163], v[104:107], v[204:207], v[160:163]
    buffer_load_dwordx4 v[192:195], v4, s[24:27], s33 offen offset:2048 sc1
    v_mfma_f32_16x16x32_bf16 v[136:139], v[108:111], v[200:203], v[136:139]
    buffer_load_dwordx4 v[196:199], v4, s[24:27], s34 offen offset:2048 sc1
    v_mfma_f32_16x16x32_bf16 v[164:167], v[108:111], v[204:207], v[164:167]
    v_mfma_f32_16x16x32_bf16 v[140:143], v[112:115], v[200:203], v[140:143]
    v_mfma_f32_16x16x32_bf16 v[168:171], v[112:115], v[204:207], v[168:171]
    v_mfma_f32_16x16x32_bf16 v[144:147], v[116:119], v[200:203], v[144:147]
    v_mfma_f32_16x16x32_bf16 v[172:175], v[116:119], v[204:207], v[172:175]
    s_waitcnt vmcnt(16) lgkmcnt(0)
    v_mfma_f32_16x16x32_bf16 v[120:123], v[64:67], v[208:211], v[120:123]
    ds_read_b128 v[92:95], v5 offset:21504
    v_mfma_f32_16x16x32_bf16 v[148:151], v[64:67], v[212:215], v[148:151]
    ds_read_b128 v[96:99], v5 offset:22528
    v_mfma_f32_16x16x32_bf16 v[124:127], v[68:71], v[208:211], v[124:127]
    ds_read_b128 v[100:103], v5 offset:23552
    v_mfma_f32_16x16x32_bf16 v[152:155], v[68:71], v[212:215], v[152:155]
    ds_read_b128 v[104:107], v5 offset:24576
    v_mfma_f32_16x16x32_bf16 v[128:131], v[72:75], v[208:211], v[128:131]
    ds_read_b128 v[108:111], v5 offset:25600
    v_mfma_f32_16x16x32_bf16 v[156:159], v[72:75], v[212:215], v[156:159]
    ds_read_b128 v[112:115], v5 offset:26624
    v_mfma_f32_16x16x32_bf16 v[132:135], v[76:79], v[208:211], v[132:135]
    ds_read_b128 v[116:119], v5 offset:27648
    v_mfma_f32_16x16x32_bf16 v[160:163], v[76:79], v[212:215], v[160:163]
    buffer_load_dwordx4 v[200:203], v4, s[24:27], s33 offen offset:3072 sc1
    s_add_u32 s33, s33, 4096
    v_mfma_f32_16x16x32_bf16 v[136:139], v[80:83], v[208:211], v[136:139]
    buffer_load_dwordx4 v[204:207], v4, s[24:27], s34 offen offset:3072 sc1
    s_add_u32 s34, s34, 4096
    v_mfma_f32_16x16x32_bf16 v[164:167], v[80:83], v[212:215], v[164:167]
    v_mfma_f32_16x16x32_bf16 v[140:143], v[84:87], v[208:211], v[140:143]
    v_mfma_f32_16x16x32_bf16 v[168:171], v[84:87], v[212:215], v[168:171]
    v_mfma_f32_16x16x32_bf16 v[144:147], v[88:91], v[208:211], v[144:147]
    v_mfma_f32_16x16x32_bf16 v[172:175], v[88:91], v[212:215], v[172:175]
    s_waitcnt vmcnt(16) lgkmcnt(0)
    v_mfma_f32_16x16x32_bf16 v[120:123], v[92:95], v[216:219], v[120:123]
    ds_read_b128 v[64:67], v5 offset:28672
    v_mfma_f32_16x16x32_bf16 v[148:151], v[92:95], v[220:223], v[148:151]
    ds_read_b128 v[68:71], v5 offset:29696
    v_mfma_f32_16x16x32_bf16 v[124:127], v[96:99], v[216:219], v[124:127]
    ds_read_b128 v[72:75], v5 offset:30720
    v_mfma_f32_16x16x32_bf16 v[152:155], v[96:99], v[220:223], v[152:155]
    ds_read_b128 v[76:79], v5 offset:31744
    v_mfma_f32_16x16x32_bf16 v[128:131], v[100:103], v[216:219], v[128:131]
    ds_read_b128 v[80:83], v5 offset:32768
    v_mfma_f32_16x16x32_bf16 v[156:159], v[100:103], v[220:223], v[156:159]
    ds_read_b128 v[84:87], v5 offset:33792
    v_mfma_f32_16x16x32_bf16 v[132:135], v[104:107], v[216:219], v[132:135]
    ds_read_b128 v[88:91], v5 offset:34816
    v_mfma_f32_16x16x32_bf16 v[160:163], v[104:107], v[220:223], v[160:163]
    v_mfma_f32_16x16x32_bf16 v[136:139], v[108:111], v[216:219], v[136:139]
    v_mfma_f32_16x16x32_bf16 v[164:167], v[108:111], v[220:223], v[164:167]
    v_mfma_f32_16x16x32_bf16 v[140:143], v[112:115], v[216:219], v[140:143]
    v_mfma_f32_16x16x32_bf16 v[168:171], v[112:115], v[220:223], v[168:171]
    v_mfma_f32_16x16x32_bf16 v[144:147], v[116:119], v[216:219], v[144:147]
    v_mfma_f32_16x16x32_bf16 v[172:175], v[116:119], v[220:223], v[172:175]
    s_waitcnt vmcnt(8)
    v_pk_add_f32 v[224:225], v[224:225], v[226:227]
    v_pk_add_f32 v[228:229], v[228:229], v[230:231]
    v_pk_add_f32 v[8:9], v[224:225], v[228:229]
    v_pk_add_f32 v[232:233], v[232:233], v[234:235]
    v_pk_add_f32 v[236:237], v[236:237], v[238:239]
    v_pk_add_f32 v[10:11], v[232:233], v[236:237]
    v_mov_b32 v12, v8
    v_mov_b32 v13, v9
    v_mov_b32 v14, v10
    v_mov_b32 v15, v11
    v_permlane32_swap_b32 v8, v12
    v_permlane32_swap_b32 v9, v13
    v_permlane32_swap_b32 v10, v14
    v_permlane32_swap_b32 v11, v15
    v_add_f32 v8, v8, v12
    v_add_f32 v9, v9, v13
    v_add_f32 v10, v10, v14
    v_add_f32 v11, v11, v15
    v_mov_b32 v12, v8
    v_mov_b32 v13, v9
    v_mov_b32 v14, v10
    v_mov_b32 v15, v11
    v_permlane16_swap_b32 v8, v12
    v_permlane16_swap_b32 v9, v13
    v_permlane16_swap_b32 v10, v14
    v_permlane16_swap_b32 v11, v15
    v_add_f32 v8, v8, v12
    v_add_f32 v9, v9, v13
    v_add_f32 v10, v10, v14
    v_add_f32 v11, v11, v15
    s_waitcnt vmcnt(6) lgkmcnt(0)
    s_barrier
    v_mfma_f32_16x16x32_bf16 v[120:123], v[64:67], v[176:179], v[120:123]
    ds_read_b128 v[92:95], v5 offset:35840
    v_mfma_f32_16x16x32_bf16 v[148:151], v[64:67], v[180:183], v[148:151]
    ds_read_b128 v[96:99], v5 offset:36864
    v_mfma_f32_16x16x32_bf16 v[124:127], v[68:71], v[176:179], v[124:127]
    ds_read_b128 v[100:103], v5 offset:37888
    v_mfma_f32_16x16x32_bf16 v[152:155], v[68:71], v[180:183], v[152:155]
    ds_read_b128 v[104:107], v5 offset:38912
    v_mfma_f32_16x16x32_bf16 v[128:131], v[72:75], v[176:179], v[128:131]
    ds_read_b128 v[108:111], v5 offset:39936
    v_mfma_f32_16x16x32_bf16 v[156:159], v[72:75], v[180:183], v[156:159]
    ds_read_b128 v[112:115], v5 offset:40960
    v_mfma_f32_16x16x32_bf16 v[132:135], v[76:79], v[176:179], v[132:135]
    ds_read_b128 v[116:119], v5 offset:41984
    v_mfma_f32_16x16x32_bf16 v[160:163], v[76:79], v[180:183], v[160:163]
    v_mfma_f32_16x16x32_bf16 v[136:139], v[80:83], v[176:179], v[136:139]
    v_mfma_f32_16x16x32_bf16 v[164:167], v[80:83], v[180:183], v[164:167]
    v_mfma_f32_16x16x32_bf16 v[140:143], v[84:87], v[176:179], v[140:143]
    v_mfma_f32_16x16x32_bf16 v[168:171], v[84:87], v[180:183], v[168:171]
    v_mfma_f32_16x16x32_bf16 v[144:147], v[88:91], v[176:179], v[144:147]
    v_mfma_f32_16x16x32_bf16 v[172:175], v[88:91], v[180:183], v[172:175]
    s_mov_b32 s40, 0x3b000000
    v_mul_f32 v8, s40, v8
    v_mul_f32 v9, s40, v9
    v_fma_f32 v9, -v8, v8, v9
    v_max_f32 v9, 0, v9
    v_add_f32 v9, 0x3727c5ac, v9
    v_rsq_f32 v9, v9
    s_nop 0
    v_mov_b32 v12, v9
    v_mul_f32 v16, -v8, v9
    v_mul_f32 v10, s40, v10
    v_mul_f32 v11, s40, v11
    v_fma_f32 v11, -v10, v10, v11
    v_max_f32 v11, 0, v11
    v_add_f32 v11, 0x3727c5ac, v11
    v_rsq_f32 v11, v11
    s_nop 0
    v_mov_b32 v14, v11
    v_mul_f32 v18, -v10, v11
    v_and_b32 v6, 1, v3
    v_lshrrev_b32 v7, 1, v3
    v_lshl_add_u32 v22, v6, 1, v7
    v_lshlrev_b32 v22, 8, v22
    v_lshl_add_u32 v20, v2, 4, v22
    s_mov_b32 s36, 57344
    v_mul_u32_u24 v6, s36, v6
    v_lshl_add_u32 v6, v7, 8, v6
    v_lshl_add_u32 v21, v2, 4, v6
    s_mul_i32 s37, s32, 57344
    s_mul_i32 s38, s28, 3584
    s_add_u32 s37, s37, s38
    s_add_u32 s37, s37, 8388608
    s_add_u32 s38, s37, 57344
    v_lshlrev_b32 v60, 4, v3
    v_add_u32 v60, 147456, v60
    ds_read_b128 v[32:35], v60 offset:0
    ds_read_b128 v[36:39], v60 offset:64
    ds_read_b128 v[40:43], v60 offset:128
    ds_read_b128 v[44:47], v60 offset:192
    ds_read_b128 v[48:51], v60 offset:256
    ds_read_b128 v[52:55], v60 offset:320
    ds_read_b128 v[56:59], v60 offset:384
    s_waitcnt vmcnt(4) lgkmcnt(0)
    v_mfma_f32_16x16x32_bf16 v[120:123], v[92:95], v[184:187], v[120:123]
    ds_read_b128 v[64:67], v5 offset:43008
    v_mfma_f32_16x16x32_bf16 v[148:151], v[92:95], v[188:191], v[148:151]
    ds_read_b128 v[68:71], v5 offset:44032
    v_mfma_f32_16x16x32_bf16 v[124:127], v[96:99], v[184:187], v[124:127]
    ds_read_b128 v[72:75], v5 offset:45056
    v_mfma_f32_16x16x32_bf16 v[152:155], v[96:99], v[188:191], v[152:155]
    ds_read_b128 v[76:79], v5 offset:46080
    v_mfma_f32_16x16x32_bf16 v[128:131], v[100:103], v[184:187], v[128:131]
    ds_read_b128 v[80:83], v5 offset:47104
    v_mfma_f32_16x16x32_bf16 v[156:159], v[100:103], v[188:191], v[156:159]
    ds_read_b128 v[84:87], v5 offset:48128
    v_mfma_f32_16x16x32_bf16 v[132:135], v[104:107], v[184:187], v[132:135]
    ds_read_b128 v[88:91], v5 offset:49152
    v_mfma_f32_16x16x32_bf16 v[160:163], v[104:107], v[188:191], v[160:163]
    v_mfma_f32_16x16x32_bf16 v[136:139], v[108:111], v[184:187], v[136:139]
    v_mfma_f32_16x16x32_bf16 v[164:167], v[108:111], v[188:191], v[164:167]
    v_mfma_f32_16x16x32_bf16 v[140:143], v[112:115], v[184:187], v[140:143]
    v_mfma_f32_16x16x32_bf16 v[168:171], v[112:115], v[188:191], v[168:171]
    v_mfma_f32_16x16x32_bf16 v[144:147], v[116:119], v[184:187], v[144:147]
    v_mfma_f32_16x16x32_bf16 v[172:175], v[116:119], v[188:191], v[172:175]
    ds_read_b128 v[92:95], v5 offset:50176
    ds_read_b128 v[96:99], v5 offset:51200
    ds_read_b128 v[100:103], v5 offset:52224
    ds_read_b128 v[104:107], v5 offset:53248
    ds_read_b128 v[108:111], v5 offset:54272
    ds_read_b128 v[112:115], v5 offset:55296
    ds_read_b128 v[116:119], v5 offset:56320
    s_mul_i32 s44, s50, 229376
    s_mul_i32 s33, s31, 14336
    s_add_u32 s44, s44, s33
    s_add_u32 s44, s44, 8388608
    s_add_u32 s33, s31, 3
    s_and_b32 s33, s33, 3
    s_mul_i32 s33, s33, 57344
    s_add_u32 s47, s44, s33
    s_add_u32 s33, s31, 2
    s_and_b32 s33, s33, 3
    s_mul_i32 s33, s33, 57344
    s_add_u32 s46, s44, s33
    s_add_u32 s33, s31, 1
    s_and_b32 s33, s33, 3
    s_mul_i32 s33, s33, 57344
    s_add_u32 s45, s44, s33
    s_add_u32 s33, s31, 0
    s_and_b32 s33, s33, 3
    s_mul_i32 s33, s33, 57344
    s_add_u32 s44, s44, s33
    s_waitcnt vmcnt(0) lgkmcnt(0)
    v_mfma_f32_16x16x32_bf16 v[120:123], v[64:67], v[192:195], v[120:123]
    v_mfma_f32_16x16x32_bf16 v[148:151], v[64:67], v[196:199], v[148:151]
    v_mfma_f32_16x16x32_bf16 v[120:123], v[92:95], v[200:203], v[120:123]
    v_mfma_f32_16x16x32_bf16 v[148:151], v[92:95], v[204:207], v[148:151]
    v_mfma_f32_16x16x32_bf16 v[124:127], v[68:71], v[192:195], v[124:127]
    v_mfma_f32_16x16x32_bf16 v[152:155], v[68:71], v[196:199], v[152:155]
    v_mfma_f32_16x16x32_bf16 v[124:127], v[96:99], v[200:203], v[124:127]
    v_mfma_f32_16x16x32_bf16 v[152:155], v[96:99], v[204:207], v[152:155]
    v_mfma_f32_16x16x32_bf16 v[128:131], v[72:75], v[192:195], v[128:131]
    s_nop 1
    v_pk_mul_f32 v[120:121], v[120:121], v[12:13] op_sel_hi:[1,0]
    v_pk_fma_f32 v[120:121], v[32:33], v[16:17], v[120:121] op_sel_hi:[1,0,1]
    v_pk_mul_f32 v[122:123], v[122:123], v[12:13] op_sel_hi:[1,0]
    v_mfma_f32_16x16x32_bf16 v[156:159], v[72:75], v[196:199], v[156:159]
    v_pk_fma_f32 v[122:123], v[34:35], v[16:17], v[122:123] op_sel_hi:[1,0,1]
    v_cvt_pk_bf16_f32 v224, v120, v121
    v_cvt_pk_bf16_f32 v225, v122, v123
    v_mfma_f32_16x16x32_bf16 v[128:131], v[100:103], v[200:203], v[128:131]
    v_pk_max_i16 v224, v224, 0
    v_pk_max_i16 v225, v225, 0
    v_pk_mul_f32 v[148:149], v[148:149], v[14:15] op_sel_hi:[1,0]
    v_mfma_f32_16x16x32_bf16 v[156:159], v[100:103], v[204:207], v[156:159]
    v_pk_fma_f32 v[148:149], v[32:33], v[18:19], v[148:149] op_sel_hi:[1,0,1]
    v_pk_mul_f32 v[150:151], v[150:151], v[14:15] op_sel_hi:[1,0]
    v_pk_fma_f32 v[150:151], v[34:35], v[18:19], v[150:151] op_sel_hi:[1,0,1]
    v_mfma_f32_16x16x32_bf16 v[132:135], v[76:79], v[192:195], v[132:135]
    v_cvt_pk_bf16_f32 v228, v148, v149
    v_cvt_pk_bf16_f32 v229, v150, v151
    v_pk_max_i16 v228, v228, 0
    v_mfma_f32_16x16x32_bf16 v[160:163], v[76:79], v[196:199], v[160:163]
    v_pk_max_i16 v229, v229, 0
    v_pk_mul_f32 v[124:125], v[124:125], v[12:13] op_sel_hi:[1,0]
    v_pk_fma_f32 v[124:125], v[36:37], v[16:17], v[124:125] op_sel_hi:[1,0,1]
    v_mfma_f32_16x16x32_bf16 v[132:135], v[104:107], v[200:203], v[132:135]
    v_pk_mul_f32 v[126:127], v[126:127], v[12:13] op_sel_hi:[1,0]
    v_pk_fma_f32 v[126:127], v[38:39], v[16:17], v[126:127] op_sel_hi:[1,0,1]
    v_cvt_pk_bf16_f32 v226, v124, v125
    v_mfma_f32_16x16x32_bf16 v[160:163], v[104:107], v[204:207], v[160:163]
    v_cvt_pk_bf16_f32 v227, v126, v127
    v_pk_max_i16 v226, v226, 0
    v_pk_max_i16 v227, v227, 0
    v_mfma_f32_16x16x32_bf16 v[136:139], v[80:83], v[192:195], v[136:139]
    v_permlane16_swap_b32 v224, v226
    v_permlane16_swap_b32 v225, v227
    buffer_store_dwordx4 v[224:227], v20, s[24:27], s37 offen offset:0 sc1
    v_mfma_f32_16x16x32_bf16 v[164:167], v[80:83], v[196:199], v[164:167]
    v_pk_mul_f32 v[152:153], v[152:153], v[14:15] op_sel_hi:[1,0]
    v_pk_fma_f32 v[152:153], v[36:37], v[18:19], v[152:153] op_sel_hi:[1,0,1]
    v_pk_mul_f32 v[154:155], v[154:155], v[14:15] op_sel_hi:[1,0]
    v_mfma_f32_16x16x32_bf16 v[136:139], v[108:111], v[200:203], v[136:139]
    v_pk_fma_f32 v[154:155], v[38:39], v[18:19], v[154:155] op_sel_hi:[1,0,1]
    v_cvt_pk_bf16_f32 v230, v152, v153
    v_cvt_pk_bf16_f32 v231, v154, v155
    v_mfma_f32_16x16x32_bf16 v[164:167], v[108:111], v[204:207], v[164:167]
    v_pk_max_i16 v230, v230, 0
    v_pk_max_i16 v231, v231, 0
    s_nop 0
    v_permlane16_swap_b32 v228, v230
    v_mfma_f32_16x16x32_bf16 v[140:143], v[84:87], v[192:195], v[140:143]
    v_permlane16_swap_b32 v229, v231
    buffer_store_dwordx4 v[228:231], v20, s[24:27], s38 offen offset:0 sc1
    v_pk_mul_f32 v[128:129], v[128:129], v[12:13] op_sel_hi:[1,0]
    v_mfma_f32_16x16x32_bf16 v[168:171], v[84:87], v[196:199], v[168:171]
    v_pk_fma_f32 v[128:129], v[40:41], v[16:17], v[128:129] op_sel_hi:[1,0,1]
    v_pk_mul_f32 v[130:131], v[130:131], v[12:13] op_sel_hi:[1,0]
    v_pk_fma_f32 v[130:131], v[42:43], v[16:17], v[130:131] op_sel_hi:[1,0,1]
    v_mfma_f32_16x16x32_bf16 v[140:143], v[112:115], v[200:203], v[140:143]
    v_cvt_pk_bf16_f32 v232, v128, v129
    v_cvt_pk_bf16_f32 v233, v130, v131
    v_pk_max_i16 v232, v232, 0
    v_mfma_f32_16x16x32_bf16 v[168:171], v[112:115], v[204:207], v[168:171]
    v_pk_max_i16 v233, v233, 0
    v_pk_mul_f32 v[156:157], v[156:157], v[14:15] op_sel_hi:[1,0]
    v_pk_fma_f32 v[156:157], v[40:41], v[18:19], v[156:157] op_sel_hi:[1,0,1]
    v_mfma_f32_16x16x32_bf16 v[144:147], v[88:91], v[192:195], v[144:147]
    v_pk_mul_f32 v[158:159], v[158:159], v[14:15] op_sel_hi:[1,0]
    v_pk_fma_f32 v[158:159], v[42:43], v[18:19], v[158:159] op_sel_hi:[1,0,1]
    v_cvt_pk_bf16_f32 v236, v156, v157
    v_mfma_f32_16x16x32_bf16 v[172:175], v[88:91], v[196:199], v[172:175]
    v_cvt_pk_bf16_f32 v237, v158, v159
    v_pk_max_i16 v236, v236, 0
    v_pk_max_i16 v237, v237, 0
    v_mfma_f32_16x16x32_bf16 v[144:147], v[116:119], v[200:203], v[144:147]
    v_pk_mul_f32 v[132:133], v[132:133], v[12:13] op_sel_hi:[1,0]
    v_pk_fma_f32 v[132:133], v[44:45], v[16:17], v[132:133] op_sel_hi:[1,0,1]
    v_pk_mul_f32 v[134:135], v[134:135], v[12:13] op_sel_hi:[1,0]
    v_mfma_f32_16x16x32_bf16 v[172:175], v[116:119], v[204:207], v[172:175]
    v_pk_fma_f32 v[134:135], v[46:47], v[16:17], v[134:135] op_sel_hi:[1,0,1]
    v_cvt_pk_bf16_f32 v234, v132, v133
    v_cvt_pk_bf16_f32 v235, v134, v135
    v_pk_max_i16 v234, v234, 0
    v_pk_max_i16 v235, v235, 0
    s_nop 0
    v_permlane16_swap_b32 v232, v234
    v_permlane16_swap_b32 v233, v235
    buffer_store_dwordx4 v[232:235], v20, s[24:27], s37 offen offset:1024 sc1
    v_pk_mul_f32 v[160:161], v[160:161], v[14:15] op_sel_hi:[1,0]
    v_pk_fma_f32 v[160:161], v[44:45], v[18:19], v[160:161] op_sel_hi:[1,0,1]
    v_pk_mul_f32 v[162:163], v[162:163], v[14:15] op_sel_hi:[1,0]
    v_pk_fma_f32 v[162:163], v[46:47], v[18:19], v[162:163] op_sel_hi:[1,0,1]
    v_cvt_pk_bf16_f32 v238, v160, v161
    v_cvt_pk_bf16_f32 v239, v162, v163
    v_pk_max_i16 v238, v238, 0
    v_pk_max_i16 v239, v239, 0
    s_nop 0
    v_permlane16_swap_b32 v236, v238
    v_permlane16_swap_b32 v237, v239
    buffer_store_dwordx4 v[236:239], v20, s[24:27], s38 offen offset:1024 sc1
    v_pk_mul_f32 v[136:137], v[136:137], v[12:13] op_sel_hi:[1,0]
    v_pk_fma_f32 v[136:137], v[48:49], v[16:17], v[136:137] op_sel_hi:[1,0,1]
    v_pk_mul_f32 v[138:139], v[138:139], v[12:13] op_sel_hi:[1,0]
    v_pk_fma_f32 v[138:139], v[50:51], v[16:17], v[138:139] op_sel_hi:[1,0,1]
    v_cvt_pk_bf16_f32 v224, v136, v137
    v_cvt_pk_bf16_f32 v225, v138, v139
    v_pk_max_i16 v224, v224, 0
    v_pk_max_i16 v225, v225, 0
    v_pk_mul_f32 v[164:165], v[164:165], v[14:15] op_sel_hi:[1,0]
    v_pk_fma_f32 v[164:165], v[48:49], v[18:19], v[164:165] op_sel_hi:[1,0,1]
    v_pk_mul_f32 v[166:167], v[166:167], v[14:15] op_sel_hi:[1,0]
    v_pk_fma_f32 v[166:167], v[50:51], v[18:19], v[166:167] op_sel_hi:[1,0,1]
    v_cvt_pk_bf16_f32 v228, v164, v165
    v_cvt_pk_bf16_f32 v229, v166, v167
    v_pk_max_i16 v228, v228, 0
    v_pk_max_i16 v229, v229, 0
    v_pk_mul_f32 v[140:141], v[140:141], v[12:13] op_sel_hi:[1,0]
    v_pk_fma_f32 v[140:141], v[52:53], v[16:17], v[140:141] op_sel_hi:[1,0,1]
    v_pk_mul_f32 v[142:143], v[142:143], v[12:13] op_sel_hi:[1,0]
    v_pk_fma_f32 v[142:143], v[54:55], v[16:17], v[142:143] op_sel_hi:[1,0,1]
    v_cvt_pk_bf16_f32 v226, v140, v141
    v_cvt_pk_bf16_f32 v227, v142, v143
    v_pk_max_i16 v226, v226, 0
    v_pk_max_i16 v227, v227, 0
    s_nop 0
    v_permlane16_swap_b32 v224, v226
    v_permlane16_swap_b32 v225, v227
    buffer_store_dwordx4 v[224:227], v20, s[24:27], s37 offen offset:2048 sc1
    v_pk_mul_f32 v[168:169], v[168:169], v[14:15] op_sel_hi:[1,0]
    v_pk_fma_f32 v[168:169], v[52:53], v[18:19], v[168:169] op_sel_hi:[1,0,1]
    v_pk_mul_f32 v[170:171], v[170:171], v[14:15] op_sel_hi:[1,0]
    v_pk_fma_f32 v[170:171], v[54:55], v[18:19], v[170:171] op_sel_hi:[1,0,1]
    v_cvt_pk_bf16_f32 v230, v168, v169
    v_cvt_pk_bf16_f32 v231, v170, v171
    v_pk_max_i16 v230, v230, 0
    v_pk_max_i16 v231, v231, 0
    s_nop 0
    v_permlane16_swap_b32 v228, v230
    v_permlane16_swap_b32 v229, v231
    buffer_store_dwordx4 v[228:231], v20, s[24:27], s38 offen offset:2048 sc1
    v_pk_mul_f32 v[144:145], v[144:145], v[12:13] op_sel_hi:[1,0]
    v_pk_fma_f32 v[144:145], v[56:57], v[16:17], v[144:145] op_sel_hi:[1,0,1]
    v_pk_mul_f32 v[146:147], v[146:147], v[12:13] op_sel_hi:[1,0]
    v_pk_fma_f32 v[146:147], v[58:59], v[16:17], v[146:147] op_sel_hi:[1,0,1]
    v_cvt_pk_bf16_f32 v240, v144, v145
    v_cvt_pk_bf16_f32 v241, v146, v147
    v_pk_max_i16 v240, v240, 0
    v_pk_max_i16 v241, v241, 0
    v_pk_mul_f32 v[172:173], v[172:173], v[14:15] op_sel_hi:[1,0]
    v_pk_fma_f32 v[172:173], v[56:57], v[18:19], v[172:173] op_sel_hi:[1,0,1]
    v_pk_mul_f32 v[174:175], v[174:175], v[14:15] op_sel_hi:[1,0]
    v_pk_fma_f32 v[174:175], v[58:59], v[18:19], v[174:175] op_sel_hi:[1,0,1]
    v_cvt_pk_bf16_f32 v242, v172, v173
    v_cvt_pk_bf16_f32 v243, v174, v175
    v_pk_max_i16 v242, v242, 0
    v_pk_max_i16 v243, v243, 0
    s_nop 0
    v_permlane16_swap_b32 v240, v242
    v_permlane16_swap_b32 v241, v243
    buffer_store_dwordx4 v[240:243], v21, s[24:27], s37 offen offset:3072 sc1
    s_lshl_b32 s36, s30, 4
    s_add_u32 s36, s36, s28
    s_lshl_b32 s36, s36, 7
    s_add_u32 s36, s36, 3702784
    s_waitcnt vmcnt(0)
    s_barrier
    s_add_u32 s52, s52, 36864
    s_lshl_b32 s37, s48, 7
    s_lshl_b32 s38, s31, 4
    v_add_u32 v6, s38, v2
    v_lshl_add_u32 v8, v6, 5, s50
    v_lshlrev_b32 v8, 10, v8
    v_and_b32 v9, 1, v3
    v_lshrrev_b32 v10, 1, v3
    v_lshl_add_u32 v9, v9, 1, v10
    v_lshl_add_u32 v10, v9, 4, s37
    v_add_u32 v14, v8, v10
    v_lshlrev_b32 v10, 4, v10
    v_lshlrev_b32 v8, 4, v2
    s_lshl_b32 s39, s50, 16
    s_lshl_b32 s38, s31, 14
    s_add_u32 s39, s39, s38
    s_add_u32 s39, s39, 4194304
    v_add_u32 v5, s53, v4
    v_add_u32 v7, 0x10000, v5
    v_add_u32 v29, 0x20000, v5
    s_barrier
    buffer_load_dwordx4 v[160:163], v4, s[24:27], s44 offen offset:0 sc1
    buffer_load_dwordx4 v[164:167], v4, s[24:27], s45 offen offset:0 sc1
    buffer_load_dwordx4 v[168:171], v4, s[24:27], s46 offen offset:0 sc1
    buffer_load_dwordx4 v[172:175], v4, s[24:27], s47 offen offset:0 sc1
    buffer_load_dwordx4 v[176:179], v4, s[24:27], s44 offen offset:1024 sc1
    buffer_load_dwordx4 v[180:183], v4, s[24:27], s45 offen offset:1024 sc1
    buffer_load_dwordx4 v[184:187], v4, s[24:27], s46 offen offset:1024 sc1
    buffer_load_dwordx4 v[188:191], v4, s[24:27], s47 offen offset:1024 sc1
    buffer_load_dwordx4 v[192:195], v4, s[24:27], s44 offen offset:2048 sc1
    buffer_load_dwordx4 v[196:199], v4, s[24:27], s45 offen offset:2048 sc1
    buffer_load_dwordx4 v[200:203], v4, s[24:27], s46 offen offset:2048 sc1
    buffer_load_dwordx4 v[204:207], v4, s[24:27], s47 offen offset:2048 sc1
    buffer_load_dwordx4 v[208:211], v4, s[24:27], s44 offen offset:3072 sc1
    s_add_u32 s44, s44, 4096
    buffer_load_dwordx4 v[212:215], v4, s[24:27], s45 offen offset:3072 sc1
    s_add_u32 s45, s45, 4096
    buffer_load_dwordx4 v[216:219], v4, s[24:27], s46 offen offset:3072 sc1
    s_add_u32 s46, s46, 4096
    buffer_load_dwordx4 v[220:223], v4, s[24:27], s47 offen offset:3072 sc1
    s_add_u32 s47, s47, 4096
    buffer_load_dwordx4 v[224:227], v4, s[24:27], s44 offen offset:0 sc1
    buffer_load_dwordx4 v[228:231], v4, s[24:27], s45 offen offset:0 sc1
    buffer_load_dwordx4 v[232:235], v4, s[24:27], s46 offen offset:0 sc1
    buffer_load_dwordx4 v[236:239], v4, s[24:27], s47 offen offset:0 sc1
    ds_read_b128 v[128:131], v7 offset:49152
    ds_read_b128 v[132:135], v7 offset:50176
    ds_read_b128 v[136:139], v7 offset:51200
    ds_read_b128 v[140:143], v7 offset:52224
    s_add_u32 s40, s31, 1
    s_and_b32 s40, s40, 3
    s_lshl_b32 s40, s40, 14
    v_add_u32 v124, s40, v5
    s_add_u32 s40, s31, 2
    s_and_b32 s40, s40, 3
    s_lshl_b32 s40, s40, 14
    v_add_u32 v125, s40, v5
    s_add_u32 s40, s31, 3
    s_and_b32 s40, s40, 3
    s_lshl_b32 s40, s40, 14
    v_add_u32 v126, s40, v5
    s_waitcnt vmcnt(16) lgkmcnt(0)
    v_mfma_f32_16x16x32_bf16 v[32:35], v[128:131], v[160:163], 0
    ds_read_b128 v[144:147], v29 offset:0
    v_mfma_f32_16x16x32_bf16 v[36:39], v[132:135], v[160:163], 0
    ds_read_b128 v[148:151], v29 offset:1024
    v_mfma_f32_16x16x32_bf16 v[40:43], v[136:139], v[160:163], 0
    ds_read_b128 v[152:155], v29 offset:2048
    v_mfma_f32_16x16x32_bf16 v[44:47], v[140:143], v[160:163], 0
    ds_read_b128 v[156:159], v29 offset:3072
    v_mfma_f32_16x16x32_bf16 v[48:51], v[128:131], v[164:167], 0
    buffer_load_dwordx4 v[240:243], v4, s[24:27], s44 offen offset:1024 sc1
    v_mfma_f32_16x16x32_bf16 v[52:55], v[132:135], v[164:167], 0
    buffer_load_dwordx4 v[244:247], v4, s[24:27], s45 offen offset:1024 sc1
    v_mfma_f32_16x16x32_bf16 v[56:59], v[136:139], v[164:167], 0
    buffer_load_dwordx4 v[248:251], v4, s[24:27], s46 offen offset:1024 sc1
    v_mfma_f32_16x16x32_bf16 v[60:63], v[140:143], v[164:167], 0
    buffer_load_dwordx4 v[252:255], v4, s[24:27], s47 offen offset:1024 sc1
    v_mfma_f32_16x16x32_bf16 v[64:67], v[128:131], v[168:171], 0
    v_mfma_f32_16x16x32_bf16 v[68:71], v[132:135], v[168:171], 0
    v_mfma_f32_16x16x32_bf16 v[72:75], v[136:139], v[168:171], 0
    v_mfma_f32_16x16x32_bf16 v[76:79], v[140:143], v[168:171], 0
    v_mfma_f32_16x16x32_bf16 v[80:83], v[128:131], v[172:175], 0
    v_mfma_f32_16x16x32_bf16 v[84:87], v[132:135], v[172:175], 0
    v_mfma_f32_16x16x32_bf16 v[88:91], v[136:139], v[172:175], 0
    v_mfma_f32_16x16x32_bf16 v[92:95], v[140:143], v[172:175], 0
    s_waitcnt vmcnt(16) lgkmcnt(0)
    v_mfma_f32_16x16x32_bf16 v[32:35], v[144:147], v[176:179], v[32:35]
    ds_read_b128 v[128:131], v5 offset:0
    v_mfma_f32_16x16x32_bf16 v[36:39], v[148:151], v[176:179], v[36:39]
    ds_read_b128 v[132:135], v5 offset:1024
    v_mfma_f32_16x16x32_bf16 v[40:43], v[152:155], v[176:179], v[40:43]
    ds_read_b128 v[136:139], v5 offset:2048
    v_mfma_f32_16x16x32_bf16 v[44:47], v[156:159], v[176:179], v[44:47]
    ds_read_b128 v[140:143], v5 offset:3072
    v_mfma_f32_16x16x32_bf16 v[48:51], v[144:147], v[180:183], v[48:51]
    buffer_load_dwordx4 v[160:163], v4, s[24:27], s44 offen offset:2048 sc1
    v_mfma_f32_16x16x32_bf16 v[52:55], v[148:151], v[180:183], v[52:55]
    buffer_load_dwordx4 v[164:167], v4, s[24:27], s45 offen offset:2048 sc1
    v_mfma_f32_16x16x32_bf16 v[56:59], v[152:155], v[180:183], v[56:59]
    buffer_load_dwordx4 v[168:171], v4, s[24:27], s46 offen offset:2048 sc1
    v_mfma_f32_16x16x32_bf16 v[60:63], v[156:159], v[180:183], v[60:63]
    buffer_load_dwordx4 v[172:175], v4, s[24:27], s47 offen offset:2048 sc1
    v_mfma_f32_16x16x32_bf16 v[64:67], v[144:147], v[184:187], v[64:67]
    v_mfma_f32_16x16x32_bf16 v[68:71], v[148:151], v[184:187], v[68:71]
    v_mfma_f32_16x16x32_bf16 v[72:75], v[152:155], v[184:187], v[72:75]
    v_mfma_f32_16x16x32_bf16 v[76:79], v[156:159], v[184:187], v[76:79]
    v_mfma_f32_16x16x32_bf16 v[80:83], v[144:147], v[188:191], v[80:83]
    v_mfma_f32_16x16x32_bf16 v[84:87], v[148:151], v[188:191], v[84:87]
    v_mfma_f32_16x16x32_bf16 v[88:91], v[152:155], v[188:191], v[88:91]
    v_mfma_f32_16x16x32_bf16 v[92:95], v[156:159], v[188:191], v[92:95]
    s_waitcnt vmcnt(16) lgkmcnt(0)
    v_mfma_f32_16x16x32_bf16 v[32:35], v[128:131], v[192:195], v[32:35]
    ds_read_b128 v[144:147], v5 offset:16384
    v_mfma_f32_16x16x32_bf16 v[36:39], v[132:135], v[192:195], v[36:39]
    ds_read_b128 v[148:151], v5 offset:17408
    v_mfma_f32_16x16x32_bf16 v[40:43], v[136:139], v[192:195], v[40:43]
    ds_read_b128 v[152:155], v5 offset:18432
    v_mfma_f32_16x16x32_bf16 v[44:47], v[140:143], v[192:195], v[44:47]
    ds_read_b128 v[156:159], v5 offset:19456
    v_mfma_f32_16x16x32_bf16 v[48:51], v[128:131], v[196:199], v[48:51]
    buffer_load_dwordx4 v[176:179], v4, s[24:27], s44 offen offset:3072 sc1
    s_add_u32 s44, s44, 4096
    v_mfma_f32_16x16x32_bf16 v[52:55], v[132:135], v[196:199], v[52:55]
    buffer_load_dwordx4 v[180:183], v4, s[24:27], s45 offen offset:3072 sc1
    s_add_u32 s45, s45, 4096
    v_mfma_f32_16x16x32_bf16 v[56:59], v[136:139], v[196:199], v[56:59]
    buffer_load_dwordx4 v[184:187], v4, s[24:27], s46 offen offset:3072 sc1
    s_add_u32 s46, s46, 4096
    v_mfma_f32_16x16x32_bf16 v[60:63], v[140:143], v[196:199], v[60:63]
    buffer_load_dwordx4 v[188:191], v4, s[24:27], s47 offen offset:3072 sc1
    s_add_u32 s47, s47, 4096
    v_mfma_f32_16x16x32_bf16 v[64:67], v[128:131], v[200:203], v[64:67]
    v_mfma_f32_16x16x32_bf16 v[68:71], v[132:135], v[200:203], v[68:71]
    v_mfma_f32_16x16x32_bf16 v[72:75], v[136:139], v[200:203], v[72:75]
    v_mfma_f32_16x16x32_bf16 v[76:79], v[140:143], v[200:203], v[76:79]
    v_mfma_f32_16x16x32_bf16 v[80:83], v[128:131], v[204:207], v[80:83]
    v_mfma_f32_16x16x32_bf16 v[84:87], v[132:135], v[204:207], v[84:87]
    v_mfma_f32_16x16x32_bf16 v[88:91], v[136:139], v[204:207], v[88:91]
    v_mfma_f32_16x16x32_bf16 v[92:95], v[140:143], v[204:207], v[92:95]
    s_waitcnt vmcnt(16) lgkmcnt(0)
    s_barrier
    v_mfma_f32_16x16x32_bf16 v[32:35], v[144:147], v[208:211], v[32:35]
    ds_read_b128 v[128:131], v5 offset:32768
    v_mfma_f32_16x16x32_bf16 v[36:39], v[148:151], v[208:211], v[36:39]
    ds_read_b128 v[132:135], v5 offset:33792
    v_mfma_f32_16x16x32_bf16 v[40:43], v[152:155], v[208:211], v[40:43]
    ds_read_b128 v[136:139], v5 offset:34816
    v_mfma_f32_16x16x32_bf16 v[44:47], v[156:159], v[208:211], v[44:47]
    ds_read_b128 v[140:143], v5 offset:35840
    v_mfma_f32_16x16x32_bf16 v[48:51], v[144:147], v[212:215], v[48:51]
    buffer_load_dwordx4 v[192:195], v4, s[24:27], s44 offen offset:0 sc1
    v_mfma_f32_16x16x32_bf16 v[52:55], v[148:151], v[212:215], v[52:55]
    buffer_load_dwordx4 v[196:199], v4, s[24:27], s45 offen offset:0 sc1
    v_mfma_f32_16x16x32_bf16 v[56:59], v[152:155], v[212:215], v[56:59]
    buffer_load_dwordx4 v[200:203], v4, s[24:27], s46 offen offset:0 sc1
    v_mfma_f32_16x16x32_bf16 v[60:63], v[156:159], v[212:215], v[60:63]
    buffer_load_dwordx4 v[204:207], v4, s[24:27], s47 offen offset:0 sc1
    v_mfma_f32_16x16x32_bf16 v[64:67], v[144:147], v[216:219], v[64:67]
    v_mfma_f32_16x16x32_bf16 v[68:71], v[148:151], v[216:219], v[68:71]
    v_mfma_f32_16x16x32_bf16 v[72:75], v[152:155], v[216:219], v[72:75]
    v_mfma_f32_16x16x32_bf16 v[76:79], v[156:159], v[216:219], v[76:79]
    v_mfma_f32_16x16x32_bf16 v[80:83], v[144:147], v[220:223], v[80:83]
    v_mfma_f32_16x16x32_bf16 v[84:87], v[148:151], v[220:223], v[84:87]
    v_mfma_f32_16x16x32_bf16 v[88:91], v[152:155], v[220:223], v[88:91]
    v_mfma_f32_16x16x32_bf16 v[92:95], v[156:159], v[220:223], v[92:95]
    s_waitcnt vmcnt(16) lgkmcnt(0)
    v_mfma_f32_16x16x32_bf16 v[32:35], v[128:131], v[224:227], v[32:35]
    ds_read_b128 v[144:147], v5 offset:49152
    v_mfma_f32_16x16x32_bf16 v[36:39], v[132:135], v[224:227], v[36:39]
    ds_read_b128 v[148:151], v5 offset:50176
    v_mfma_f32_16x16x32_bf16 v[40:43], v[136:139], v[224:227], v[40:43]
    ds_read_b128 v[152:155], v5 offset:51200
    v_mfma_f32_16x16x32_bf16 v[44:47], v[140:143], v[224:227], v[44:47]
    ds_read_b128 v[156:159], v5 offset:52224
    v_mfma_f32_16x16x32_bf16 v[48:51], v[128:131], v[228:231], v[48:51]
    buffer_load_dwordx4 v[208:211], v4, s[24:27], s44 offen offset:1024 sc1
    v_mfma_f32_16x16x32_bf16 v[52:55], v[132:135], v[228:231], v[52:55]
    buffer_load_dwordx4 v[212:215], v4, s[24:27], s45 offen offset:1024 sc1
    v_mfma_f32_16x16x32_bf16 v[56:59], v[136:139], v[228:231], v[56:59]
    buffer_load_dwordx4 v[216:219], v4, s[24:27], s46 offen offset:1024 sc1
    v_mfma_f32_16x16x32_bf16 v[60:63], v[140:143], v[228:231], v[60:63]
    buffer_load_dwordx4 v[220:223], v4, s[24:27], s47 offen offset:1024 sc1
    v_mfma_f32_16x16x32_bf16 v[64:67], v[128:131], v[232:235], v[64:67]
    v_mfma_f32_16x16x32_bf16 v[68:71], v[132:135], v[232:235], v[68:71]
    v_mfma_f32_16x16x32_bf16 v[72:75], v[136:139], v[232:235], v[72:75]
    v_mfma_f32_16x16x32_bf16 v[76:79], v[140:143], v[232:235], v[76:79]
    v_mfma_f32_16x16x32_bf16 v[80:83], v[128:131], v[236:239], v[80:83]
    v_mfma_f32_16x16x32_bf16 v[84:87], v[132:135], v[236:239], v[84:87]
    v_mfma_f32_16x16x32_bf16 v[88:91], v[136:139], v[236:239], v[88:91]
    v_mfma_f32_16x16x32_bf16 v[92:95], v[140:143], v[236:239], v[92:95]
    s_waitcnt vmcnt(16) lgkmcnt(0)
    v_mfma_f32_16x16x32_bf16 v[32:35], v[144:147], v[240:243], v[32:35]
    ds_read_b128 v[128:131], v7 offset:0
    v_mfma_f32_16x16x32_bf16 v[36:39], v[148:151], v[240:243], v[36:39]
    ds_read_b128 v[132:135], v7 offset:1024
    v_mfma_f32_16x16x32_bf16 v[40:43], v[152:155], v[240:243], v[40:43]
    ds_read_b128 v[136:139], v7 offset:2048
    v_mfma_f32_16x16x32_bf16 v[44:47], v[156:159], v[240:243], v[44:47]
    ds_read_b128 v[140:143], v7 offset:3072
    v_mfma_f32_16x16x32_bf16 v[48:51], v[144:147], v[244:247], v[48:51]
    buffer_load_dwordx4 v[224:227], v4, s[24:27], s44 offen offset:2048 sc1
    v_mfma_f32_16x16x32_bf16 v[52:55], v[148:151], v[244:247], v[52:55]
    buffer_load_dwordx4 v[228:231], v4, s[24:27], s45 offen offset:2048 sc1
    v_mfma_f32_16x16x32_bf16 v[56:59], v[152:155], v[244:247], v[56:59]
    buffer_load_dwordx4 v[232:235], v4, s[24:27], s46 offen offset:2048 sc1
    v_mfma_f32_16x16x32_bf16 v[60:63], v[156:159], v[244:247], v[60:63]
    buffer_load_dwordx4 v[236:239], v4, s[24:27], s47 offen offset:2048 sc1
    v_mfma_f32_16x16x32_bf16 v[64:67], v[144:147], v[248:251], v[64:67]
    v_mfma_f32_16x16x32_bf16 v[68:71], v[148:151], v[248:251], v[68:71]
    v_mfma_f32_16x16x32_bf16 v[72:75], v[152:155], v[248:251], v[72:75]
    v_mfma_f32_16x16x32_bf16 v[76:79], v[156:159], v[248:251], v[76:79]
    v_mfma_f32_16x16x32_bf16 v[80:83], v[144:147], v[252:255], v[80:83]
    v_mfma_f32_16x16x32_bf16 v[84:87], v[148:151], v[252:255], v[84:87]
    v_mfma_f32_16x16x32_bf16 v[88:91], v[152:155], v[252:255], v[88:91]
    v_mfma_f32_16x16x32_bf16 v[92:95], v[156:159], v[252:255], v[92:95]
    s_waitcnt vmcnt(16) lgkmcnt(0)
    s_barrier
    v_mfma_f32_16x16x32_bf16 v[32:35], v[128:131], v[160:163], v[32:35]
    ds_read_b128 v[144:147], v7 offset:16384
    v_mfma_f32_16x16x32_bf16 v[36:39], v[132:135], v[160:163], v[36:39]
    ds_read_b128 v[148:151], v7 offset:17408
    v_mfma_f32_16x16x32_bf16 v[40:43], v[136:139], v[160:163], v[40:43]
    ds_read_b128 v[152:155], v7 offset:18432
    v_mfma_f32_16x16x32_bf16 v[44:47], v[140:143], v[160:163], v[44:47]
    ds_read_b128 v[156:159], v7 offset:19456
    v_mfma_f32_16x16x32_bf16 v[48:51], v[128:131], v[164:167], v[48:51]
    buffer_load_dwordx4 v[240:243], v4, s[24:27], s44 offen offset:3072 sc1
    s_add_u32 s44, s44, 4096
    v_mfma_f32_16x16x32_bf16 v[52:55], v[132:135], v[164:167], v[52:55]
    buffer_load_dwordx4 v[244:247], v4, s[24:27], s45 offen offset:3072 sc1
    s_add_u32 s45, s45, 4096
    v_mfma_f32_16x16x32_bf16 v[56:59], v[136:139], v[164:167], v[56:59]
    buffer_load_dwordx4 v[248:251], v4, s[24:27], s46 offen offset:3072 sc1
    s_add_u32 s46, s46, 4096
    v_mfma_f32_16x16x32_bf16 v[60:63], v[140:143], v[164:167], v[60:63]
    buffer_load_dwordx4 v[252:255], v4, s[24:27], s47 offen offset:3072 sc1
    s_add_u32 s47, s47, 4096
    v_mfma_f32_16x16x32_bf16 v[64:67], v[128:131], v[168:171], v[64:67]
    v_mfma_f32_16x16x32_bf16 v[68:71], v[132:135], v[168:171], v[68:71]
    v_mfma_f32_16x16x32_bf16 v[72:75], v[136:139], v[168:171], v[72:75]
    v_mfma_f32_16x16x32_bf16 v[76:79], v[140:143], v[168:171], v[76:79]
    v_mfma_f32_16x16x32_bf16 v[80:83], v[128:131], v[172:175], v[80:83]
    v_mfma_f32_16x16x32_bf16 v[84:87], v[132:135], v[172:175], v[84:87]
    v_mfma_f32_16x16x32_bf16 v[88:91], v[136:139], v[172:175], v[88:91]
    v_mfma_f32_16x16x32_bf16 v[92:95], v[140:143], v[172:175], v[92:95]
    s_waitcnt vmcnt(16) lgkmcnt(0)
    v_mfma_f32_16x16x32_bf16 v[32:35], v[144:147], v[176:179], v[32:35]
    ds_read_b128 v[128:131], v7 offset:32768
    v_mfma_f32_16x16x32_bf16 v[36:39], v[148:151], v[176:179], v[36:39]
    ds_read_b128 v[132:135], v7 offset:33792
    v_mfma_f32_16x16x32_bf16 v[40:43], v[152:155], v[176:179], v[40:43]
    ds_read_b128 v[136:139], v7 offset:34816
    v_mfma_f32_16x16x32_bf16 v[44:47], v[156:159], v[176:179], v[44:47]
    ds_read_b128 v[140:143], v7 offset:35840
    v_mfma_f32_16x16x32_bf16 v[48:51], v[144:147], v[180:183], v[48:51]
    buffer_load_dwordx4 v[160:163], v4, s[24:27], s44 offen offset:0 sc1
    v_mfma_f32_16x16x32_bf16 v[52:55], v[148:151], v[180:183], v[52:55]
    buffer_load_dwordx4 v[164:167], v4, s[24:27], s45 offen offset:0 sc1
    v_mfma_f32_16x16x32_bf16 v[56:59], v[152:155], v[180:183], v[56:59]
    buffer_load_dwordx4 v[168:171], v4, s[24:27], s46 offen offset:0 sc1
    v_mfma_f32_16x16x32_bf16 v[60:63], v[156:159], v[180:183], v[60:63]
    buffer_load_dwordx4 v[172:175], v4, s[24:27], s47 offen offset:0 sc1
    v_mfma_f32_16x16x32_bf16 v[64:67], v[144:147], v[184:187], v[64:67]
    v_mfma_f32_16x16x32_bf16 v[68:71], v[148:151], v[184:187], v[68:71]
    v_mfma_f32_16x16x32_bf16 v[72:75], v[152:155], v[184:187], v[72:75]
    v_mfma_f32_16x16x32_bf16 v[76:79], v[156:159], v[184:187], v[76:79]
    v_mfma_f32_16x16x32_bf16 v[80:83], v[144:147], v[188:191], v[80:83]
    v_mfma_f32_16x16x32_bf16 v[84:87], v[148:151], v[188:191], v[84:87]
    v_mfma_f32_16x16x32_bf16 v[88:91], v[152:155], v[188:191], v[88:91]
    v_mfma_f32_16x16x32_bf16 v[92:95], v[156:159], v[188:191], v[92:95]
    s_waitcnt vmcnt(16) lgkmcnt(0)
    v_mfma_f32_16x16x32_bf16 v[32:35], v[128:131], v[192:195], v[32:35]
    ds_read_b128 v[144:147], v7 offset:49152
    v_mfma_f32_16x16x32_bf16 v[36:39], v[132:135], v[192:195], v[36:39]
    ds_read_b128 v[148:151], v7 offset:50176
    v_mfma_f32_16x16x32_bf16 v[40:43], v[136:139], v[192:195], v[40:43]
    ds_read_b128 v[152:155], v7 offset:51200
    v_mfma_f32_16x16x32_bf16 v[44:47], v[140:143], v[192:195], v[44:47]
    ds_read_b128 v[156:159], v7 offset:52224
    v_mfma_f32_16x16x32_bf16 v[48:51], v[128:131], v[196:199], v[48:51]
    buffer_load_dwordx4 v[176:179], v4, s[24:27], s44 offen offset:1024 sc1
    v_mfma_f32_16x16x32_bf16 v[52:55], v[132:135], v[196:199], v[52:55]
    buffer_load_dwordx4 v[180:183], v4, s[24:27], s45 offen offset:1024 sc1
    v_mfma_f32_16x16x32_bf16 v[56:59], v[136:139], v[196:199], v[56:59]
    buffer_load_dwordx4 v[184:187], v4, s[24:27], s46 offen offset:1024 sc1
    v_mfma_f32_16x16x32_bf16 v[60:63], v[140:143], v[196:199], v[60:63]
    buffer_load_dwordx4 v[188:191], v4, s[24:27], s47 offen offset:1024 sc1
    v_mfma_f32_16x16x32_bf16 v[64:67], v[128:131], v[200:203], v[64:67]
    v_mfma_f32_16x16x32_bf16 v[68:71], v[132:135], v[200:203], v[68:71]
    v_mfma_f32_16x16x32_bf16 v[72:75], v[136:139], v[200:203], v[72:75]
    v_mfma_f32_16x16x32_bf16 v[76:79], v[140:143], v[200:203], v[76:79]
    v_mfma_f32_16x16x32_bf16 v[80:83], v[128:131], v[204:207], v[80:83]
    v_mfma_f32_16x16x32_bf16 v[84:87], v[132:135], v[204:207], v[84:87]
    v_mfma_f32_16x16x32_bf16 v[88:91], v[136:139], v[204:207], v[88:91]
    v_mfma_f32_16x16x32_bf16 v[92:95], v[140:143], v[204:207], v[92:95]
    s_waitcnt vmcnt(16) lgkmcnt(0)
    s_barrier
    v_mfma_f32_16x16x32_bf16 v[32:35], v[144:147], v[208:211], v[32:35]
    ds_read_b128 v[128:131], v29 offset:0
    v_mfma_f32_16x16x32_bf16 v[36:39], v[148:151], v[208:211], v[36:39]
    ds_read_b128 v[132:135], v29 offset:1024
    v_mfma_f32_16x16x32_bf16 v[40:43], v[152:155], v[208:211], v[40:43]
    ds_read_b128 v[136:139], v29 offset:2048
    v_mfma_f32_16x16x32_bf16 v[44:47], v[156:159], v[208:211], v[44:47]
    ds_read_b128 v[140:143], v29 offset:3072
    v_mfma_f32_16x16x32_bf16 v[48:51], v[144:147], v[212:215], v[48:51]
    v_mfma_f32_16x16x32_bf16 v[52:55], v[148:151], v[212:215], v[52:55]
    v_mfma_f32_16x16x32_bf16 v[56:59], v[152:155], v[212:215], v[56:59]
    v_mfma_f32_16x16x32_bf16 v[60:63], v[156:159], v[212:215], v[60:63]
    v_mfma_f32_16x16x32_bf16 v[64:67], v[144:147], v[216:219], v[64:67]
    v_mfma_f32_16x16x32_bf16 v[68:71], v[148:151], v[216:219], v[68:71]
    v_mfma_f32_16x16x32_bf16 v[72:75], v[152:155], v[216:219], v[72:75]
    v_mfma_f32_16x16x32_bf16 v[76:79], v[156:159], v[216:219], v[76:79]
    v_mfma_f32_16x16x32_bf16 v[80:83], v[144:147], v[220:223], v[80:83]
    v_mfma_f32_16x16x32_bf16 v[84:87], v[148:151], v[220:223], v[84:87]
    v_mfma_f32_16x16x32_bf16 v[88:91], v[152:155], v[220:223], v[88:91]
    v_mfma_f32_16x16x32_bf16 v[92:95], v[156:159], v[220:223], v[92:95]
    s_waitcnt vmcnt(12) lgkmcnt(0)
    v_mfma_f32_16x16x32_bf16 v[32:35], v[128:131], v[224:227], v[32:35]
    ds_read_b128 v[144:147], v5 offset:0
    v_mfma_f32_16x16x32_bf16 v[36:39], v[132:135], v[224:227], v[36:39]
    ds_read_b128 v[148:151], v5 offset:1024
    v_mfma_f32_16x16x32_bf16 v[40:43], v[136:139], v[224:227], v[40:43]
    ds_read_b128 v[152:155], v5 offset:2048
    v_mfma_f32_16x16x32_bf16 v[44:47], v[140:143], v[224:227], v[44:47]
    ds_read_b128 v[156:159], v5 offset:3072
    v_mfma_f32_16x16x32_bf16 v[48:51], v[128:131], v[228:231], v[48:51]
    v_mfma_f32_16x16x32_bf16 v[52:55], v[132:135], v[228:231], v[52:55]
    v_mfma_f32_16x16x32_bf16 v[56:59], v[136:139], v[228:231], v[56:59]
    v_mfma_f32_16x16x32_bf16 v[60:63], v[140:143], v[228:231], v[60:63]
    v_mfma_f32_16x16x32_bf16 v[64:67], v[128:131], v[232:235], v[64:67]
    v_mfma_f32_16x16x32_bf16 v[68:71], v[132:135], v[232:235], v[68:71]
    v_mfma_f32_16x16x32_bf16 v[72:75], v[136:139], v[232:235], v[72:75]
    v_mfma_f32_16x16x32_bf16 v[76:79], v[140:143], v[232:235], v[76:79]
    v_mfma_f32_16x16x32_bf16 v[80:83], v[128:131], v[236:239], v[80:83]
    v_mfma_f32_16x16x32_bf16 v[84:87], v[132:135], v[236:239], v[84:87]
    v_mfma_f32_16x16x32_bf16 v[88:91], v[136:139], v[236:239], v[88:91]
    v_mfma_f32_16x16x32_bf16 v[92:95], v[140:143], v[236:239], v[92:95]
    s_cmp_ge_u32 s48, 4
    s_cbranch_scc1 KC_MIR
    v_add_u32 v15, v8, v10
    buffer_load_dwordx4 v[16:19], v15, s[24:27], s39 offen sc1
    buffer_load_dwordx4 v[20:23], v15, s[24:27], s39 offen offset:1024 sc1
    buffer_load_dword v24, v15, s[24:27], s39 offen sc1
    buffer_load_dword v25, v15, s[24:27], s39 offen sc1
    s_branch KC_RED
KC_MIR:
    v_sub_u32 v15, 0x5b00, v10
    v_add_u32 v15, v8, v15
    buffer_load_dwordx4 v[16:19], v15, s[24:27], s39 offen offset:1024 sc1
    buffer_load_dwordx4 v[20:23], v15, s[24:27], s39 offen sc1
    v_sub_u32 v26, 0x6000, v10
    v_mov_b32 v27, 0x4000
    v_cmp_eq_u32 vcc, v26, v27
    v_mov_b32 v27, 0x2000
    s_nop 0
    v_cndmask_b32 v26, v26, v27, vcc
    v_add_u32 v26, v8, v26
    buffer_load_dword v24, v26, s[24:27], s39 offen sc1
    buffer_load_dword v25, v15, s[24:27], s39 offen offset:256 sc1
KC_RED:
    s_waitcnt vmcnt(12) lgkmcnt(0)
    v_mfma_f32_16x16x32_bf16 v[32:35], v[144:147], v[240:243], v[32:35]
    ds_read_b128 v[128:131], v5 offset:16384
    v_mfma_f32_16x16x32_bf16 v[36:39], v[148:151], v[240:243], v[36:39]
    ds_read_b128 v[132:135], v5 offset:17408
    v_mfma_f32_16x16x32_bf16 v[40:43], v[152:155], v[240:243], v[40:43]
    ds_read_b128 v[136:139], v5 offset:18432
    v_mfma_f32_16x16x32_bf16 v[44:47], v[156:159], v[240:243], v[44:47]
    ds_read_b128 v[140:143], v5 offset:19456
    v_mfma_f32_16x16x32_bf16 v[48:51], v[144:147], v[244:247], v[48:51]
    v_mfma_f32_16x16x32_bf16 v[52:55], v[148:151], v[244:247], v[52:55]
    v_mfma_f32_16x16x32_bf16 v[56:59], v[152:155], v[244:247], v[56:59]
    v_mfma_f32_16x16x32_bf16 v[60:63], v[156:159], v[244:247], v[60:63]
    v_mfma_f32_16x16x32_bf16 v[64:67], v[144:147], v[248:251], v[64:67]
    v_mfma_f32_16x16x32_bf16 v[68:71], v[148:151], v[248:251], v[68:71]
    v_mfma_f32_16x16x32_bf16 v[72:75], v[152:155], v[248:251], v[72:75]
    v_mfma_f32_16x16x32_bf16 v[76:79], v[156:159], v[248:251], v[76:79]
    v_mfma_f32_16x16x32_bf16 v[80:83], v[144:147], v[252:255], v[80:83]
    v_mfma_f32_16x16x32_bf16 v[84:87], v[148:151], v[252:255], v[84:87]
    v_mfma_f32_16x16x32_bf16 v[88:91], v[152:155], v[252:255], v[88:91]
    v_mfma_f32_16x16x32_bf16 v[92:95], v[156:159], v[252:255], v[92:95]
    s_waitcnt vmcnt(8) lgkmcnt(0)
    v_mfma_f32_16x16x32_bf16 v[32:35], v[128:131], v[160:163], v[32:35]
    ds_read_b128 v[144:147], v5 offset:32768
    v_mfma_f32_16x16x32_bf16 v[36:39], v[132:135], v[160:163], v[36:39]
    ds_read_b128 v[148:151], v5 offset:33792
    v_mfma_f32_16x16x32_bf16 v[40:43], v[136:139], v[160:163], v[40:43]
    ds_read_b128 v[152:155], v5 offset:34816
    v_mfma_f32_16x16x32_bf16 v[44:47], v[140:143], v[160:163], v[44:47]
    ds_read_b128 v[156:159], v5 offset:35840
    v_mfma_f32_16x16x32_bf16 v[48:51], v[128:131], v[164:167], v[48:51]
    v_mfma_f32_16x16x32_bf16 v[52:55], v[132:135], v[164:167], v[52:55]
    v_mfma_f32_16x16x32_bf16 v[56:59], v[136:139], v[164:167], v[56:59]
    v_mfma_f32_16x16x32_bf16 v[60:63], v[140:143], v[164:167], v[60:63]
    v_mfma_f32_16x16x32_bf16 v[64:67], v[128:131], v[168:171], v[64:67]
    v_mfma_f32_16x16x32_bf16 v[68:71], v[132:135], v[168:171], v[68:71]
    v_mfma_f32_16x16x32_bf16 v[72:75], v[136:139], v[168:171], v[72:75]
    v_mfma_f32_16x16x32_bf16 v[76:79], v[140:143], v[168:171], v[76:79]
    v_mfma_f32_16x16x32_bf16 v[80:83], v[128:131], v[172:175], v[80:83]
    v_mfma_f32_16x16x32_bf16 v[84:87], v[132:135], v[172:175], v[84:87]
    v_mfma_f32_16x16x32_bf16 v[88:91], v[136:139], v[172:175], v[88:91]
    v_mfma_f32_16x16x32_bf16 v[92:95], v[140:143], v[172:175], v[92:95]
    s_waitcnt vmcnt(4) lgkmcnt(0)
    v_mfma_f32_16x16x32_bf16 v[48:51], v[144:147], v[180:183], v[48:51]
    v_mfma_f32_16x16x32_bf16 v[52:55], v[148:151], v[180:183], v[52:55]
    v_mfma_f32_16x16x32_bf16 v[56:59], v[152:155], v[180:183], v[56:59]
    v_mfma_f32_16x16x32_bf16 v[60:63], v[156:159], v[180:183], v[60:63]
    v_mfma_f32_16x16x32_bf16 v[64:67], v[144:147], v[184:187], v[64:67]
    v_mfma_f32_16x16x32_bf16 v[68:71], v[148:151], v[184:187], v[68:71]
    v_mfma_f32_16x16x32_bf16 v[72:75], v[152:155], v[184:187], v[72:75]
    v_mfma_f32_16x16x32_bf16 v[76:79], v[156:159], v[184:187], v[76:79]
    v_mfma_f32_16x16x32_bf16 v[80:83], v[144:147], v[188:191], v[80:83]
    ds_write_b128 v124, v[48:51] offset:0
    v_mfma_f32_16x16x32_bf16 v[84:87], v[148:151], v[188:191], v[84:87]
    ds_write_b128 v124, v[52:55] offset:1024
    v_mfma_f32_16x16x32_bf16 v[88:91], v[152:155], v[188:191], v[88:91]
    ds_write_b128 v124, v[56:59] offset:2048
    v_mfma_f32_16x16x32_bf16 v[92:95], v[156:159], v[188:191], v[92:95]
    ds_write_b128 v124, v[60:63] offset:3072
    v_mfma_f32_16x16x32_bf16 v[32:35], v[144:147], v[176:179], v[32:35]
    ds_write_b128 v125, v[64:67] offset:0
    ds_write_b128 v125, v[68:71] offset:1024
    v_mfma_f32_16x16x32_bf16 v[36:39], v[148:151], v[176:179], v[36:39]
    ds_write_b128 v125, v[72:75] offset:2048
    ds_write_b128 v125, v[76:79] offset:3072
    v_mfma_f32_16x16x32_bf16 v[40:43], v[152:155], v[176:179], v[40:43]
    ds_write_b128 v126, v[80:83] offset:0
    ds_write_b128 v126, v[84:87] offset:1024
    v_mfma_f32_16x16x32_bf16 v[44:47], v[156:159], v[176:179], v[44:47]
    ds_write_b128 v126, v[88:91] offset:2048
    ds_write_b128 v126, v[92:95] offset:3072
    s_lshl_b32 s41, s31, 14
    s_waitcnt lgkmcnt(0)
    s_barrier
    s_add_u32 s40, s31, 1
    s_and_b32 s40, s40, 3
    s_lshl_b32 s40, s40, 12
    s_add_u32 s40, s40, s41
    v_add_u32 v28, s40, v4
    ds_read_b128 v[48:51], v28 offset:0
    ds_read_b128 v[52:55], v28 offset:1024
    ds_read_b128 v[56:59], v28 offset:2048
    ds_read_b128 v[60:63], v28 offset:3072
    s_add_u32 s40, s31, 2
    s_and_b32 s40, s40, 3
    s_lshl_b32 s40, s40, 12
    s_add_u32 s40, s40, s41
    v_add_u32 v28, s40, v4
    ds_read_b128 v[64:67], v28 offset:0
    ds_read_b128 v[68:71], v28 offset:1024
    ds_read_b128 v[72:75], v28 offset:2048
    ds_read_b128 v[76:79], v28 offset:3072
    s_add_u32 s40, s31, 3
    s_and_b32 s40, s40, 3
    s_lshl_b32 s40, s40, 12
    s_add_u32 s40, s40, s41
    v_add_u32 v28, s40, v4
    ds_read_b128 v[80:83], v28 offset:0
    ds_read_b128 v[84:87], v28 offset:1024
    ds_read_b128 v[88:91], v28 offset:2048
    ds_read_b128 v[92:95], v28 offset:3072
    s_mov_b32 s41, 0xffff0000
    s_waitcnt lgkmcnt(8)
    v_pk_add_f32 v[32:33], v[32:33], v[48:49]
    v_pk_add_f32 v[34:35], v[34:35], v[50:51]
    v_pk_add_f32 v[36:37], v[36:37], v[52:53]
    v_pk_add_f32 v[38:39], v[38:39], v[54:55]
    v_pk_add_f32 v[40:41], v[40:41], v[56:57]
    v_pk_add_f32 v[42:43], v[42:43], v[58:59]
    v_pk_add_f32 v[44:45], v[44:45], v[60:61]
    v_pk_add_f32 v[46:47], v[46:47], v[62:63]
    s_waitcnt lgkmcnt(0)
    v_pk_add_f32 v[64:65], v[64:65], v[80:81]
    v_pk_add_f32 v[66:67], v[66:67], v[82:83]
    v_pk_add_f32 v[68:69], v[68:69], v[84:85]
    v_pk_add_f32 v[70:71], v[70:71], v[86:87]
    v_pk_add_f32 v[72:73], v[72:73], v[88:89]
    v_pk_add_f32 v[74:75], v[74:75], v[90:91]
    v_pk_add_f32 v[76:77], v[76:77], v[92:93]
    v_pk_add_f32 v[78:79], v[78:79], v[94:95]
    v_pk_add_f32 v[32:33], v[32:33], v[64:65]
    v_pk_add_f32 v[34:35], v[34:35], v[66:67]
    v_pk_add_f32 v[36:37], v[36:37], v[68:69]
    v_pk_add_f32 v[38:39], v[38:39], v[70:71]
    v_pk_add_f32 v[40:41], v[40:41], v[72:73]
    v_pk_add_f32 v[42:43], v[42:43], v[74:75]
    v_pk_add_f32 v[44:45], v[44:45], v[76:77]
    v_pk_add_f32 v[46:47], v[46:47], v[78:79]
    v_permlane16_swap_b32 v32, v36
    v_permlane16_swap_b32 v33, v37
    v_permlane16_swap_b32 v34, v38
    v_permlane16_swap_b32 v35, v39
    v_permlane16_swap_b32 v40, v44
    v_permlane16_swap_b32 v41, v45
    v_permlane16_swap_b32 v42, v46
    v_permlane16_swap_b32 v43, v47
    s_waitcnt vmcnt(0)
    s_cmp_ge_u32 s48, 4
    s_cbranch_scc1 KC_MIR2
    v_lshlrev_b32 v30, 16, v16
    v_and_b32 v31, s41, v16
    v_pk_add_f32 v[30:31], v[30:31], v[32:33]
    v_cvt_pk_bf16_f32 v64, v30, v31
    v_lshlrev_b32 v30, 16, v17
    v_and_b32 v31, s41, v17
    v_pk_add_f32 v[30:31], v[30:31], v[34:35]
    v_cvt_pk_bf16_f32 v65, v30, v31
    v_lshlrev_b32 v30, 16, v18
    v_and_b32 v31, s41, v18
    v_pk_add_f32 v[30:31], v[30:31], v[36:37]
    v_cvt_pk_bf16_f32 v66, v30, v31
    v_lshlrev_b32 v30, 16, v19
    v_and_b32 v31, s41, v19
    v_pk_add_f32 v[30:31], v[30:31], v[38:39]
    v_cvt_pk_bf16_f32 v67, v30, v31
    v_lshlrev_b32 v30, 16, v20
    v_and_b32 v31, s41, v20
    v_pk_add_f32 v[30:31], v[30:31], v[40:41]
    v_cvt_pk_bf16_f32 v68, v30, v31
    v_lshlrev_b32 v30, 16, v21
    v_and_b32 v31, s41, v21
    v_pk_add_f32 v[30:31], v[30:31], v[42:43]
    v_cvt_pk_bf16_f32 v69, v30, v31
    v_lshlrev_b32 v30, 16, v22
    v_and_b32 v31, s41, v22
    v_pk_add_f32 v[30:31], v[30:31], v[44:45]
    v_cvt_pk_bf16_f32 v70, v30, v31
    v_lshlrev_b32 v30, 16, v23
    v_and_b32 v31, s41, v23
    v_pk_add_f32 v[30:31], v[30:31], v[46:47]
    v_cvt_pk_bf16_f32 v71, v30, v31
    s_branch KC_ST
KC_MIR2:
    v_lshlrev_b32 v30, 16, v24
    v_and_b32 v31, s41, v19
    v_pk_add_f32 v[30:31], v[30:31], v[32:33]
    v_cvt_pk_bf16_f32 v64, v30, v31
    v_lshlrev_b32 v30, 16, v19
    v_and_b32 v31, s41, v18
    v_pk_add_f32 v[30:31], v[30:31], v[34:35]
    v_cvt_pk_bf16_f32 v65, v30, v31
    v_lshlrev_b32 v30, 16, v18
    v_and_b32 v31, s41, v17
    v_pk_add_f32 v[30:31], v[30:31], v[36:37]
    v_cvt_pk_bf16_f32 v66, v30, v31
    v_lshlrev_b32 v30, 16, v17
    v_and_b32 v31, s41, v16
    v_pk_add_f32 v[30:31], v[30:31], v[38:39]
    v_cvt_pk_bf16_f32 v67, v30, v31
    v_lshlrev_b32 v30, 16, v25
    v_and_b32 v31, s41, v23
    v_pk_add_f32 v[30:31], v[30:31], v[40:41]
    v_cvt_pk_bf16_f32 v68, v30, v31
    v_lshlrev_b32 v30, 16, v23
    v_and_b32 v31, s41, v22
    v_pk_add_f32 v[30:31], v[30:31], v[42:43]
    v_cvt_pk_bf16_f32 v69, v30, v31
    v_lshlrev_b32 v30, 16, v22
    v_and_b32 v31, s41, v21
    v_pk_add_f32 v[30:31], v[30:31], v[44:45]
    v_cvt_pk_bf16_f32 v70, v30, v31
    v_lshlrev_b32 v30, 16, v21
    v_and_b32 v31, s41, v20
    v_pk_add_f32 v[30:31], v[30:31], v[46:47]
    v_cvt_pk_bf16_f32 v71, v30, v31
KC_ST:
    buffer_store_dwordx4 v[64:67], v14, s[16:19], 0 offen
    buffer_store_dwordx4 v[68:71], v14, s[16:19], 0 offen offset:64
KC_END:
    s_endpgm
.section .rodata,"a"
.p2align 6
.amdhsa_kernel sequential_preLN__spectral_fnet__dense_activation_relu__prompt_kernel
  .amdhsa_next_free_vgpr 256
  .amdhsa_next_free_sgpr 80
  .amdhsa_accum_offset 256
  .amdhsa_group_segment_fixed_size 0
  .amdhsa_kernarg_size 88
  .amdhsa_user_sgpr_count 2
  .amdhsa_user_sgpr_kernarg_segment_ptr 1
  .amdhsa_system_sgpr_workgroup_id_x 1
  .amdhsa_float_denorm_mode_32 3
.end_amdhsa_kernel
```
